```python
import torch

def _softmax(x, axis=-1):
    return torch.softmax(x, dim=axis)
def _gelu(x):
    return torch.nn.functional.gelu(x, approximate="tanh")
def _silu(x):
    return torch.nn.functional.silu(x)
def _sigmoid(x):
    return torch.sigmoid(x)
def _layernorm(x, axis=-1, eps=1e-5):
    m = x.mean(dim=axis, keepdim=True)
    v = x.var(dim=axis, keepdim=True, unbiased=False)
    return (x - m) / torch.sqrt(v + eps)
def _scatter_add(tgt, idx, src, axis=0):
    return tgt.clone().index_add_(axis, idx, src)
def _segment_sum(src, seg, n):
    out = torch.zeros((n,) + src.shape[1:], dtype=src.dtype)
    return out.index_add_(0, seg, src)
def _pad(x, pw):
    flat = tuple(v for pair in reversed(pw) for v in pair)
    return torch.nn.functional.pad(x, flat)

kernel_name = 'parallel_sum__spectral_fnet__dense_activation_relu__prompt'

def setup_inputs():

    _w = (lambda a: (lambda t: t.to(torch.bfloat16) if t.is_floating_point() else t)(torch.as_tensor(a)))
    def _A_setup():
        B, S, D = 1, 2048, 512
        ns = torch.arange(S)[:, None] * torch.arange(S)[None, :]
        nd = torch.arange(D)[:, None] * torch.arange(D)[None, :]
        Ws_re = torch.cos(-2.0 * torch.pi * ns / S).to(float)
        Ws_im = torch.sin(-2.0 * torch.pi * ns / S).to(float)
        Wd_re = torch.cos(-2.0 * torch.pi * nd / D).to(float)
        Wd_im = torch.sin(-2.0 * torch.pi * nd / D).to(float)
        return {
            "x": _w((lambda *s: torch.randn(*s, dtype=torch.bfloat16) * 0.05)(B, S, D)),
            "dft_seq_re": _w(Ws_re),
            "dft_seq_im": _w(Ws_im),
            "dft_hid_re": _w(Wd_re),
            "dft_hid_im": _w(Wd_im),
        }
    _A_in = _A_setup()

    def _B_setup():
        B, S, D, Dff = 1, 2048, 512, 1792
        return {
            "x": _w((lambda *s: torch.randn(*s, dtype=torch.bfloat16) * 0.05)(B, S, D)),
            "w1": _w((lambda *s: torch.randn(*s, dtype=torch.bfloat16) * 0.4)(D, Dff)),
            "w2": _w((lambda *s: torch.randn(*s, dtype=torch.bfloat16) * 0.4)(Dff, D)),
        }
    _B_in = _B_setup()

    return {
        "A_x": _A_in["x"],
        "A_dft_seq_re": _A_in["dft_seq_re"],
        "A_dft_seq_im": _A_in["dft_seq_im"],
        "A_dft_hid_re": _A_in["dft_hid_re"],
        "A_dft_hid_im": _A_in["dft_hid_im"],
        "B_x": _B_in["x"],
        "B_w1": _B_in["w1"],
        "B_w2": _B_in["w2"],
    }

def reference(A_x, A_dft_seq_re, A_dft_seq_im, A_dft_hid_re, A_dft_hid_im, B_x, B_w1, B_w2):
    def _A_ref(x, dft_seq_re, dft_seq_im, dft_hid_re, dft_hid_im):
        a = torch.einsum("bsd,ed->bse", x, dft_hid_re)
        b = torch.einsum("bsd,ed->bse", x, dft_hid_im)
        y = torch.einsum("ts,bse->bte", dft_seq_re, a) - torch.einsum("ts,bse->bte", dft_seq_im, b)
        return y

    def _B_ref(x, w1, w2):
        h = torch.einsum("bsd,df->bsf", x, w1)
        zero = torch.zeros_like(h)
        h = torch.maximum(h, zero)
        return torch.einsum("bsf,fd->bsd", h, w2)

    x = A_x
    xn = _layernorm(x, axis=-1)
    return x + _A_ref(xn, A_dft_seq_re, A_dft_seq_im, A_dft_hid_re, A_dft_hid_im) + _B_ref(xn, B_w1, B_w2)
```

```asm
; @launch kernel=fnet_ka_kernel grid=(256,1,1) block=(256,1,1) lds=163840
; @launch kernel=fnet_kb_kernel grid=(256,1,1) block=(256,1,1) lds=160896
.amdgcn_target "amdgcn-amd-amdhsa--gfx950"
.text
.globl fnet_ka_kernel
.p2align 8
.type fnet_ka_kernel,@function
fnet_ka_kernel:
    s_cmp_ge_u32 s2, 256
    s_cbranch_scc1 KA_END
    s_load_dwordx2 s[4:5], s[0:1], 0
    s_load_dwordx4 s[12:15], s[0:1], 48
    s_load_dwordx4 s[8:11], s[0:1], 24
    s_load_dwordx2 s[16:17], s[0:1], 80
    s_load_dwordx4 s[76:79], s[0:1], 8
    s_and_b32 s3, s2, 7
    s_lshr_b32 s18, s2, 3
    s_and_b32 s19, s3, 3
    s_lshl_b32 s19, s19, 2
    s_and_b32 s20, s18, 3
    s_add_u32 s19, s19, s20
    s_lshr_b32 s20, s3, 2
    s_lshl_b32 s20, s20, 3
    s_lshr_b32 s21, s18, 2
    s_add_u32 s20, s20, s21
    v_lshrrev_b32 v1, 6, v0
    v_and_b32 v0, 63, v0
    v_and_b32 v2, 15, v0
    v_readfirstlane_b32 s21, v1
    v_lshrrev_b32 v3, 4, v0
    s_mov_b32 s61, 3584
    s_lshl_b32 s22, s19, 6
    s_lshl_b32 s23, s21, 4
    s_add_u32 s22, s22, s23
    v_lshrrev_b32 v20, 3, v0
    v_lshrrev_b32 v21, 4, v0
    v_and_b32 v22, 7, v0
    v_mov_b32 v6, 0x400
    v_add_u32 v23, 0, v20
    v_add_u32 v23, s22, v23
    v_xor_b32 v24, 0, v21
    v_xor_b32 v24, v22, v24
    v_lshlrev_b32 v24, 4, v24
    v_lshl_add_u32 v12, v23, 10, v24
    v_sub_u32 v25, 0x800, v23
    v_cmp_eq_u32 vcc, 0, v23
    s_nop 1
    v_cndmask_b32 v25, v25, v6, vcc
    v_lshl_add_u32 v14, v25, 10, v24
    v_add_u32 v23, 8, v20
    v_add_u32 v23, s22, v23
    v_xor_b32 v24, 4, v21
    v_xor_b32 v24, v22, v24
    v_lshlrev_b32 v24, 4, v24
    v_lshl_add_u32 v13, v23, 10, v24
    v_sub_u32 v25, 0x800, v23
    v_cmp_eq_u32 vcc, 0, v23
    s_nop 1
    v_cndmask_b32 v25, v25, v6, vcc
    v_lshl_add_u32 v15, v25, 10, v24
    s_mul_i32 s59, s20, 224
    s_mov_b32 s60, 4682
    s_and_b32 s62, s21, 1
    s_add_u32 s62, s62, 12
    s_add_u32 s63, s21, 0
    s_lshl_b32 s63, s63, 6
    v_add_u32 v28, s63, v0
    v_mul_lo_u32 v29, v28, s60
    v_lshrrev_b32 v29, 16, v29
    v_mul_u32_u24 v30, 14, v29
    v_sub_u32 v30, v28, v30
    v_and_b32 v31, 0x33, v29
    v_and_b32 v32, 4, v29
    v_lshlrev_b32 v32, 1, v32
    v_and_b32 v33, 8, v29
    v_lshrrev_b32 v33, 1, v33
    v_or3_b32 v31, v31, v32, v33
    v_mul_lo_u32 v31, v31, s61
    v_lshl_add_u32 v31, v30, 4, v31
    v_add_u32 v16, s59, v31
    s_add_u32 s63, s21, 4
    s_lshl_b32 s63, s63, 6
    v_add_u32 v28, s63, v0
    v_mul_lo_u32 v29, v28, s60
    v_lshrrev_b32 v29, 16, v29
    v_mul_u32_u24 v30, 14, v29
    v_sub_u32 v30, v28, v30
    v_and_b32 v31, 0x33, v29
    v_and_b32 v32, 4, v29
    v_lshlrev_b32 v32, 1, v32
    v_and_b32 v33, 8, v29
    v_lshrrev_b32 v33, 1, v33
    v_or3_b32 v31, v31, v32, v33
    v_mul_lo_u32 v31, v31, s61
    v_lshl_add_u32 v31, v30, 4, v31
    v_add_u32 v17, s59, v31
    s_add_u32 s63, s21, 8
    s_lshl_b32 s63, s63, 6
    v_add_u32 v28, s63, v0
    v_mul_lo_u32 v29, v28, s60
    v_lshrrev_b32 v29, 16, v29
    v_mul_u32_u24 v30, 14, v29
    v_sub_u32 v30, v28, v30
    v_and_b32 v31, 0x33, v29
    v_and_b32 v32, 4, v29
    v_lshlrev_b32 v32, 1, v32
    v_and_b32 v33, 8, v29
    v_lshrrev_b32 v33, 1, v33
    v_or3_b32 v31, v31, v32, v33
    v_mul_lo_u32 v31, v31, s61
    v_lshl_add_u32 v31, v30, 4, v31
    v_add_u32 v18, s59, v31
    s_mov_b32 s63, s62
    s_lshl_b32 s63, s63, 6
    v_add_u32 v28, s63, v0
    v_mul_lo_u32 v29, v28, s60
    v_lshrrev_b32 v29, 16, v29
    v_mul_u32_u24 v30, 14, v29
    v_sub_u32 v30, v28, v30
    v_and_b32 v31, 0x33, v29
    v_and_b32 v32, 4, v29
    v_lshlrev_b32 v32, 1, v32
    v_and_b32 v33, 8, v29
    v_lshrrev_b32 v33, 1, v33
    v_or3_b32 v31, v31, v32, v33
    v_mul_lo_u32 v31, v31, s61
    v_lshl_add_u32 v31, v30, 4, v31
    v_add_u32 v19, s59, v31
    s_cmp_lt_u32 s21, 2
    s_cselect_b64 s[68:69], -1, 1
    s_lshl_b32 s72, s21, 12
    s_lshl_b32 s73, s21, 10
    s_lshl_b32 s67, s62, 10
    s_lshr_b32 s75, s2, 3
    s_waitcnt lgkmcnt(0)
    s_mov_b32 s24, s4
    s_mov_b32 s25, s5
    s_and_b32 s25, s25, 0xffff
    s_mov_b32 s26, 2097152
    s_mov_b32 s27, 0x00020000
    s_mov_b32 s28, s12
    s_mov_b32 s29, s13
    s_and_b32 s29, s29, 0xffff
    s_mov_b32 s30, 1835008
    s_mov_b32 s31, 0x00020000
    s_mov_b32 s63, 0
    s_add_u32 m0, s72, 33792
    s_nop 0
    buffer_load_dwordx4 v12, s[24:27], s63 offen lds
    s_mov_b32 s63, 0
    s_add_u32 m0, s72, 34816
    s_nop 0
    buffer_load_dwordx4 v13, s[24:27], s63 offen lds
    s_mov_b32 s63, 0
    s_add_u32 m0, s72, 35840
    s_nop 0
    buffer_load_dwordx4 v14, s[24:27], s63 offen lds
    s_mov_b32 s63, 0
    s_add_u32 m0, s72, 36864
    s_nop 0
    buffer_load_dwordx4 v15, s[24:27], s63 offen lds
    s_mov_b32 s63, 0
    s_add_u32 m0, s73, 50176
    s_nop 0
    buffer_load_dwordx4 v16, s[28:31], s63 offen lds
    s_mov_b32 s63, 0
    s_add_u32 m0, s73, 54272
    s_nop 0
    buffer_load_dwordx4 v17, s[28:31], s63 offen lds
    s_mov_b32 s63, 0
    s_add_u32 m0, s73, 58368
    s_nop 0
    buffer_load_dwordx4 v18, s[28:31], s63 offen lds
    s_mov_b32 s63, 0
    s_add_u32 m0, s67, 50176
    s_mov_b64 exec, s[68:69]
    buffer_load_dwordx4 v19, s[28:31], s63 offen lds
    s_mov_b64 exec, -1
    s_cmp_lt_u32 s20, 8
    s_cselect_b32 s36, s8, s10
    s_cselect_b32 s37, s9, s11
    s_and_b32 s37, s37, 0xffff
    s_mov_b32 s38, 524288
    s_mov_b32 s39, 0x00020000
    s_cmp_eq_u32 s21, 0
    s_cselect_b32 s58, 9, 8
    s_cmp_lt_u32 s20, s58
    s_cselect_b32 s32, s8, s10
    s_cselect_b32 s33, s9, s11
    s_and_b32 s33, s33, 0xffff
    s_mov_b32 s34, 524288
    s_mov_b32 s35, 0x00020000
    s_lshl_b32 s23, s20, 5
    s_lshl_b32 s56, s21, 3
    s_add_u32 s23, s23, s56
    s_lshl_b32 s23, s23, 10
    v_lshlrev_b32 v10, 4, v0
    s_mul_i32 s57, s56, 1056
    s_add_u32 s57, s57, 0
    s_add_u32 m0, s57, 0
    s_add_u32 s58, s23, 0
    buffer_load_dwordx4 v10, s[32:35], s58 offen lds
    s_add_u32 m0, s57, 1056
    s_add_u32 s58, s23, 1024
    buffer_load_dwordx4 v10, s[36:39], s58 offen lds
    s_add_u32 m0, s57, 2112
    s_add_u32 s58, s23, 2048
    buffer_load_dwordx4 v10, s[36:39], s58 offen lds
    s_add_u32 m0, s57, 3168
    s_add_u32 s58, s23, 3072
    buffer_load_dwordx4 v10, s[36:39], s58 offen lds
    s_add_u32 m0, s57, 4224
    s_add_u32 s58, s23, 4096
    buffer_load_dwordx4 v10, s[36:39], s58 offen lds
    s_add_u32 m0, s57, 5280
    s_add_u32 s58, s23, 5120
    buffer_load_dwordx4 v10, s[36:39], s58 offen lds
    s_add_u32 m0, s57, 6336
    s_add_u32 s58, s23, 6144
    buffer_load_dwordx4 v10, s[36:39], s58 offen lds
    s_add_u32 m0, s57, 7392
    s_add_u32 s58, s23, 7168
    buffer_load_dwordx4 v10, s[36:39], s58 offen lds
    s_mov_b32 s63, 128
    s_add_u32 m0, s72, 64512
    s_nop 0
    buffer_load_dwordx4 v12, s[24:27], s63 offen lds
    s_mov_b32 s63, 128
    s_add_u32 m0, s72, 65536
    s_nop 0
    buffer_load_dwordx4 v13, s[24:27], s63 offen lds
    s_mov_b32 s63, 128
    s_add_u32 m0, s72, 66560
    s_nop 0
    buffer_load_dwordx4 v14, s[24:27], s63 offen lds
    s_mov_b32 s63, 128
    s_add_u32 m0, s72, 67584
    s_nop 0
    buffer_load_dwordx4 v15, s[24:27], s63 offen lds
    s_mov_b32 s63, 229376
    s_add_u32 m0, s73, 80896
    s_nop 0
    buffer_load_dwordx4 v16, s[28:31], s63 offen lds
    s_mov_b32 s63, 229376
    s_add_u32 m0, s73, 84992
    s_nop 0
    buffer_load_dwordx4 v17, s[28:31], s63 offen lds
    s_mov_b32 s63, 229376
    s_add_u32 m0, s73, 89088
    s_nop 0
    buffer_load_dwordx4 v18, s[28:31], s63 offen lds
    s_mov_b32 s63, 229376
    s_add_u32 m0, s67, 80896
    s_mov_b64 exec, s[68:69]
    buffer_load_dwordx4 v19, s[28:31], s63 offen lds
    s_mov_b64 exec, -1
    s_mov_b32 s40, s14
    s_mov_b32 s41, s15
    s_and_b32 s41, s41, 0xffff
    s_mov_b32 s42, 1835008
    s_mov_b32 s43, 0x00020000
    v_lshrrev_b32 v26, 2, v0
    v_and_b32 v27, 3, v0
    v_lshlrev_b32 v27, 4, v27
    v_lshl_add_u32 v26, v26, 10, v27
    s_mul_i32 s64, s20, 112
    s_lshl_b32 s65, s21, 4
    s_add_u32 s64, s64, s65
    s_lshl_b32 s64, s64, 10
    s_lshl_b32 s65, s19, 6
    s_add_u32 s64, s64, s65
    s_mov_b32 s44, s16
    s_mov_b32 s45, s17
    s_and_b32 s45, s45, 0xffff
    s_mov_b32 s46, 7340032
    s_mov_b32 s47, 0x00020000
    s_add_u32 s48, s16, 8388608
    s_addc_u32 s49, s17, 0
    s_and_b32 s49, s49, 0xffff
    s_mov_b32 s50, 1114112
    s_mov_b32 s51, 0x00020000
    s_add_u32 s52, s16, 10485760
    s_addc_u32 s53, s17, 0
    s_and_b32 s53, s53, 0xffff
    s_mov_b32 s54, 1835008
    s_mov_b32 s55, 0x00020000
    v_mov_b32 v92, 0x3f803f80
    v_mov_b32 v93, 0x3f803f80
    v_mov_b32 v94, 0x3f803f80
    v_mov_b32 v95, 0x3f803f80
    v_accvgpr_write_b32 a0, 0
    v_accvgpr_write_b32 a1, 0
    v_accvgpr_write_b32 a2, 0
    v_accvgpr_write_b32 a3, 0
    v_accvgpr_write_b32 a4, 0
    v_accvgpr_write_b32 a5, 0
    v_accvgpr_write_b32 a6, 0
    v_accvgpr_write_b32 a7, 0
    v_accvgpr_write_b32 a8, 0
    v_accvgpr_write_b32 a9, 0
    v_accvgpr_write_b32 a10, 0
    v_accvgpr_write_b32 a11, 0
    v_accvgpr_write_b32 a12, 0
    v_accvgpr_write_b32 a13, 0
    v_accvgpr_write_b32 a14, 0
    v_accvgpr_write_b32 a15, 0
    v_accvgpr_write_b32 a16, 0
    v_accvgpr_write_b32 a17, 0
    v_accvgpr_write_b32 a18, 0
    v_accvgpr_write_b32 a19, 0
    v_accvgpr_write_b32 a20, 0
    v_accvgpr_write_b32 a21, 0
    v_accvgpr_write_b32 a22, 0
    v_accvgpr_write_b32 a23, 0
    v_accvgpr_write_b32 a24, 0
    v_accvgpr_write_b32 a25, 0
    v_accvgpr_write_b32 a26, 0
    v_accvgpr_write_b32 a27, 0
    v_accvgpr_write_b32 a28, 0
    v_accvgpr_write_b32 a29, 0
    v_accvgpr_write_b32 a30, 0
    v_accvgpr_write_b32 a31, 0
    v_accvgpr_write_b32 a32, 0
    v_accvgpr_write_b32 a33, 0
    v_accvgpr_write_b32 a34, 0
    v_accvgpr_write_b32 a35, 0
    v_accvgpr_write_b32 a36, 0
    v_accvgpr_write_b32 a37, 0
    v_accvgpr_write_b32 a38, 0
    v_accvgpr_write_b32 a39, 0
    v_accvgpr_write_b32 a40, 0
    v_accvgpr_write_b32 a41, 0
    v_accvgpr_write_b32 a42, 0
    v_accvgpr_write_b32 a43, 0
    v_accvgpr_write_b32 a44, 0
    v_accvgpr_write_b32 a45, 0
    v_accvgpr_write_b32 a46, 0
    v_accvgpr_write_b32 a47, 0
    v_accvgpr_write_b32 a48, 0
    v_accvgpr_write_b32 a49, 0
    v_accvgpr_write_b32 a50, 0
    v_accvgpr_write_b32 a51, 0
    v_add_u32 v4, s22, v2
    v_sub_u32 v5, 0x800, v4
    v_cmp_eq_u32 vcc, 0, v4
    s_nop 1
    v_cndmask_b32 v5, v5, v6, vcc
    v_lshrrev_b32 v44, 1, v3
    v_lshlrev_b32 v44, 4, v44
    v_and_b32 v45, 1, v3
    v_lshl_add_u32 v44, v45, 2, v44
    v_lshrrev_b32 v45, 2, v2
    v_add_u32 v44, v44, v45
    v_mul_u32_u24 v44, 224, v44
    v_and_b32 v45, 3, v0
    v_lshl_add_u32 v44, v45, 3, v44
    v_lshrrev_b32 v45, 1, v2
    v_xor_b32 v45, v45, v3
    v_lshlrev_b32 v45, 4, v45
    v_lshl_add_u32 v45, v2, 7, v45
    v_add_u32 v45, s72, v45
    v_xor_b32 v43, 64, v45
    v_mul_u32_u24 v46, 1056, v2
    v_lshl_add_u32 v46, v3, 4, v46
    v_add_u32 v46, 0, v46
    v_mov_b32 v176, 0
    v_mov_b32 v177, 0
    v_mov_b32 v178, 0
    v_mov_b32 v179, 0
    v_mov_b32 v180, 0
    v_mov_b32 v181, 0
    v_mov_b32 v182, 0
    v_mov_b32 v183, 0
    v_mov_b32 v184, 0
    v_mov_b32 v185, 0
    v_mov_b32 v186, 0
    v_mov_b32 v187, 0
    v_mov_b32 v188, 0
    v_mov_b32 v189, 0
    v_mov_b32 v190, 0
    v_mov_b32 v191, 0
    v_mov_b32 v192, 0
    v_mov_b32 v193, 0
    v_mov_b32 v194, 0
    v_mov_b32 v195, 0
    v_mov_b32 v196, 0
    v_mov_b32 v197, 0
    v_mov_b32 v198, 0
    v_mov_b32 v199, 0
    v_mov_b32 v200, 0
    v_mov_b32 v201, 0
    v_mov_b32 v202, 0
    v_mov_b32 v203, 0
    v_mov_b32 v204, 0
    v_mov_b32 v205, 0
    v_mov_b32 v206, 0
    v_mov_b32 v207, 0
    v_mov_b32 v208, 0
    v_mov_b32 v209, 0
    v_mov_b32 v210, 0
    v_mov_b32 v211, 0
    v_mov_b32 v212, 0
    v_mov_b32 v213, 0
    v_mov_b32 v214, 0
    v_mov_b32 v215, 0
    v_mov_b32 v216, 0
    v_mov_b32 v217, 0
    v_mov_b32 v218, 0
    v_mov_b32 v219, 0
    v_mov_b32 v220, 0
    v_mov_b32 v221, 0
    v_mov_b32 v222, 0
    v_mov_b32 v223, 0
    v_mov_b32 v224, 0
    v_mov_b32 v225, 0
    v_mov_b32 v226, 0
    v_mov_b32 v227, 0
    v_mov_b32 v228, 0
    v_mov_b32 v229, 0
    v_mov_b32 v230, 0
    v_mov_b32 v231, 0
    v_mov_b32 v232, 0
    v_mov_b32 v233, 0
    v_mov_b32 v234, 0
    v_mov_b32 v235, 0
    v_mov_b32 v236, 0
    v_mov_b32 v237, 0
    v_mov_b32 v238, 0
    v_mov_b32 v239, 0
    v_mov_b32 v240, 0
    v_mov_b32 v241, 0
    v_mov_b32 v242, 0
    v_mov_b32 v243, 0
    v_mov_b32 v244, 0
    v_mov_b32 v245, 0
    v_mov_b32 v246, 0
    v_mov_b32 v247, 0
    v_and_b32 v47, 1, v3
    v_lshlrev_b32 v47, 3, v47
    v_lshrrev_b32 v48, 2, v2
    v_add_u32 v47, v47, v48
    v_lshlrev_b32 v47, 6, v47
    v_lshrrev_b32 v48, 1, v3
    v_lshl_add_u32 v47, v48, 5, v47
    v_and_b32 v48, 3, v0
    v_lshl_add_u32 v47, v48, 3, v47
    v_add_u32 v47, s73, v47
    v_add_u32 v47, 156672, v47
    s_mul_i32 s65, s20, 224
    v_mul_lo_u32 v61, v4, s61
    v_lshl_add_u32 v61, v3, 3, v61
    v_add_u32 v61, s65, v61
    v_mul_lo_u32 v64, v5, s61
    v_lshl_add_u32 v64, v3, 3, v64
    v_add_u32 v64, s65, v64
    v_lshlrev_b32 v80, 4, v3
    v_add_u32 v81, 0, v80
    v_add_u32 v82, 4, v80
    v_add_u32 v83, 8, v80
    v_add_u32 v84, 12, v80
    v_mov_b32 v62, 0
    v_mov_b32 v63, 1.0
    v_mov_b32 v68, -1.0
    s_lshl_b32 s65, s20, 5
    v_add_u32 v65, s65, v2
    s_mov_b32 s66, 2176
    v_mul_lo_u32 v66, v65, s66
    v_add_u32 v67, 0x800, v66
    v_lshl_add_u32 v85, v3, 2, s22
    v_lshl_add_u32 v66, v85, 1, v66
    v_cmp_ne_u32 vcc, 0, v85
    s_nop 1
    v_cndmask_b32 v86, v62, v63, vcc
    s_lshl_b32 s23, s2, 2
    s_add_u32 s23, s23, s21
    s_lshl_b32 s23, s23, 12
    s_waitcnt vmcnt(8)
    s_barrier
    v_add_u32 v58, 50176, v44
    v_add_u32 v59, 33792, v45
    v_add_u32 v60, 33792, v43
    ds_read_b128 v[136:139], v59 offset:0
    ds_read_b128 v[140:143], v59 offset:2048
    ds_read_b64_tr_b16 v[96:97], v58 offset:0
    ds_read_b64_tr_b16 v[98:99], v58 offset:1792
    ds_read_b64_tr_b16 v[100:101], v58 offset:32
    ds_read_b64_tr_b16 v[102:103], v58 offset:1824
    ds_read_b64_tr_b16 v[104:105], v58 offset:64
    ds_read_b64_tr_b16 v[106:107], v58 offset:1856
    ds_read_b64_tr_b16 v[108:109], v58 offset:96
    ds_read_b64_tr_b16 v[110:111], v58 offset:1888
    ds_read_b64_tr_b16 v[112:113], v58 offset:128
    ds_read_b64_tr_b16 v[114:115], v58 offset:1920
    ds_read_b64_tr_b16 v[116:117], v58 offset:160
    ds_read_b64_tr_b16 v[118:119], v58 offset:1952
    ds_read_b64_tr_b16 v[120:121], v58 offset:192
    ds_read_b64_tr_b16 v[122:123], v58 offset:1984
    ds_read_b128 v[124:127], v46 offset:0
    ds_read_b128 v[128:131], v46 offset:16896
    s_waitcnt lgkmcnt(14)
    v_mfma_f32_16x16x32_bf16 v[176:179], v[96:99], v[136:139], v[176:179]
    v_mfma_f32_16x16x32_bf16 v[180:183], v[96:99], v[140:143], v[180:183]
    v_mfma_f32_16x16x32_bf16 a[0:3], v[96:99], v[92:95], a[0:3]
    s_mov_b32 s63, 256
    s_add_u32 m0, s72, 95232
    s_nop 0
    buffer_load_dwordx4 v12, s[24:27], s63 offen lds
    ds_read_b128 v[144:147], v60 offset:0
    s_waitcnt lgkmcnt(13)
    v_mfma_f32_16x16x32_bf16 v[184:187], v[100:103], v[136:139], v[184:187]
    v_mfma_f32_16x16x32_bf16 v[188:191], v[100:103], v[140:143], v[188:191]
    v_mfma_f32_16x16x32_bf16 a[4:7], v[100:103], v[92:95], a[4:7]
    v_mfma_f32_16x16x32_bf16 a[36:39], v[92:95], v[136:139], a[36:39]
    s_mov_b32 s63, 256
    s_add_u32 m0, s72, 96256
    s_nop 0
    buffer_load_dwordx4 v13, s[24:27], s63 offen lds
    ds_read_b128 v[148:151], v60 offset:2048
    s_waitcnt lgkmcnt(12)
    v_mfma_f32_16x16x32_bf16 v[192:195], v[104:107], v[136:139], v[192:195]
    v_mfma_f32_16x16x32_bf16 v[196:199], v[104:107], v[140:143], v[196:199]
    v_mfma_f32_16x16x32_bf16 a[8:11], v[104:107], v[92:95], a[8:11]
    s_mov_b32 s63, 256
    s_add_u32 m0, s72, 97280
    s_nop 0
    buffer_load_dwordx4 v14, s[24:27], s63 offen lds
    ds_read_b64_tr_b16 v[132:133], v58 offset:7168
    ds_read_b64_tr_b16 v[134:135], v58 offset:8960
    s_waitcnt lgkmcnt(12)
    v_mfma_f32_16x16x32_bf16 v[200:203], v[108:111], v[136:139], v[200:203]
    v_mfma_f32_16x16x32_bf16 v[204:207], v[108:111], v[140:143], v[204:207]
    v_mfma_f32_16x16x32_bf16 a[12:15], v[108:111], v[92:95], a[12:15]
    v_mfma_f32_16x16x32_bf16 a[44:47], v[136:139], v[136:139], a[44:47]
    s_mov_b32 s63, 256
    s_add_u32 m0, s72, 98304
    s_nop 0
    buffer_load_dwordx4 v15, s[24:27], s63 offen lds
    ds_read_b64_tr_b16 v[96:97], v58 offset:7200
    ds_read_b64_tr_b16 v[98:99], v58 offset:8992
    s_waitcnt lgkmcnt(12)
    v_mfma_f32_16x16x32_bf16 v[208:211], v[112:115], v[136:139], v[208:211]
    v_mfma_f32_16x16x32_bf16 v[212:215], v[112:115], v[140:143], v[212:215]
    v_mfma_f32_16x16x32_bf16 a[16:19], v[112:115], v[92:95], a[16:19]
    s_mov_b32 s63, 458752
    s_add_u32 m0, s73, 111616
    s_nop 0
    buffer_load_dwordx4 v16, s[28:31], s63 offen lds
    ds_read_b64_tr_b16 v[100:101], v58 offset:7232
    ds_read_b64_tr_b16 v[102:103], v58 offset:9024
    s_waitcnt lgkmcnt(12)
    v_mfma_f32_16x16x32_bf16 v[216:219], v[116:119], v[136:139], v[216:219]
    v_mfma_f32_16x16x32_bf16 v[220:223], v[116:119], v[140:143], v[220:223]
    v_mfma_f32_16x16x32_bf16 a[20:23], v[116:119], v[92:95], a[20:23]
    v_mfma_f32_16x16x32_bf16 a[40:43], v[92:95], v[140:143], a[40:43]
    s_mov_b32 s63, 458752
    s_add_u32 m0, s73, 115712
    s_nop 0
    buffer_load_dwordx4 v17, s[28:31], s63 offen lds
    ds_read_b64_tr_b16 v[104:105], v58 offset:7264
    ds_read_b64_tr_b16 v[106:107], v58 offset:9056
    s_waitcnt lgkmcnt(12)
    v_mfma_f32_16x16x32_bf16 v[224:227], v[120:123], v[136:139], v[224:227]
    v_mfma_f32_16x16x32_bf16 v[228:231], v[120:123], v[140:143], v[228:231]
    v_mfma_f32_16x16x32_bf16 a[24:27], v[120:123], v[92:95], a[24:27]
    s_mov_b32 s63, 458752
    s_add_u32 m0, s73, 119808
    s_nop 0
    buffer_load_dwordx4 v18, s[28:31], s63 offen lds
    ds_read_b64_tr_b16 v[108:109], v58 offset:7296
    ds_read_b64_tr_b16 v[110:111], v58 offset:9088
    s_waitcnt lgkmcnt(13)
    v_mfma_f32_16x16x32_bf16 v[232:235], v[136:139], v[124:127], v[232:235]
    v_mfma_f32_16x16x32_bf16 v[236:239], v[140:143], v[124:127], v[236:239]
    v_mfma_f32_16x16x32_bf16 a[28:31], v[92:95], v[124:127], a[28:31]
    v_mfma_f32_16x16x32_bf16 a[48:51], v[140:143], v[140:143], a[48:51]
    s_mov_b32 s63, 458752
    s_add_u32 m0, s67, 111616
    s_mov_b64 exec, s[68:69]
    buffer_load_dwordx4 v19, s[28:31], s63 offen lds
    s_mov_b64 exec, -1
    ds_read_b64_tr_b16 v[112:113], v58 offset:7328
    ds_read_b64_tr_b16 v[114:115], v58 offset:9120
    s_waitcnt lgkmcnt(14)
    v_mfma_f32_16x16x32_bf16 v[240:243], v[136:139], v[128:131], v[240:243]
    v_mfma_f32_16x16x32_bf16 v[244:247], v[140:143], v[128:131], v[244:247]
    v_mfma_f32_16x16x32_bf16 a[32:35], v[92:95], v[128:131], a[32:35]
    s_mov_b32 s63, 384
    s_add_u32 m0, s72, 125952
    s_nop 0
    buffer_load_dwordx4 v12, s[24:27], s63 offen lds
    ds_read_b64_tr_b16 v[116:117], v58 offset:7360
    ds_read_b64_tr_b16 v[118:119], v58 offset:9152
    ds_read_b128 v[120:123], v46 offset:64
    ds_read_b128 v[124:127], v46 offset:16960
    s_waitcnt lgkmcnt(14)
    v_mfma_f32_16x16x32_bf16 v[176:179], v[132:135], v[144:147], v[176:179]
    v_mfma_f32_16x16x32_bf16 v[180:183], v[132:135], v[148:151], v[180:183]
    v_mfma_f32_16x16x32_bf16 a[0:3], v[132:135], v[92:95], a[0:3]
    s_mov_b32 s63, 384
    s_add_u32 m0, s72, 126976
    s_nop 0
    buffer_load_dwordx4 v13, s[24:27], s63 offen lds
    s_waitcnt vmcnt(10)
    s_barrier
    v_add_u32 v58, 80896, v44
    v_add_u32 v59, 64512, v45
    v_add_u32 v60, 64512, v43
    ds_read_b128 v[152:155], v59 offset:0
    s_waitcnt lgkmcnt(13)
    v_mfma_f32_16x16x32_bf16 v[184:187], v[96:99], v[144:147], v[184:187]
    v_mfma_f32_16x16x32_bf16 v[188:191], v[96:99], v[148:151], v[188:191]
    v_mfma_f32_16x16x32_bf16 a[4:7], v[96:99], v[92:95], a[4:7]
    v_mfma_f32_16x16x32_bf16 a[36:39], v[92:95], v[144:147], a[36:39]
    ds_read_b128 v[156:159], v59 offset:2048
    s_waitcnt lgkmcnt(12)
    v_mfma_f32_16x16x32_bf16 v[192:195], v[100:103], v[144:147], v[192:195]
    v_mfma_f32_16x16x32_bf16 v[196:199], v[100:103], v[148:151], v[196:199]
    v_mfma_f32_16x16x32_bf16 a[8:11], v[100:103], v[92:95], a[8:11]
    s_mov_b32 s63, 384
    s_add_u32 m0, s72, 128000
    s_nop 0
    buffer_load_dwordx4 v14, s[24:27], s63 offen lds
    ds_read_b64_tr_b16 v[128:129], v58 offset:0
    ds_read_b64_tr_b16 v[130:131], v58 offset:1792
    s_waitcnt lgkmcnt(12)
    v_mfma_f32_16x16x32_bf16 v[200:203], v[104:107], v[144:147], v[200:203]
    v_mfma_f32_16x16x32_bf16 v[204:207], v[104:107], v[148:151], v[204:207]
    v_mfma_f32_16x16x32_bf16 a[12:15], v[104:107], v[92:95], a[12:15]
    v_mfma_f32_16x16x32_bf16 a[44:47], v[144:147], v[144:147], a[44:47]
    ds_read_b64_tr_b16 v[132:133], v58 offset:32
    ds_read_b64_tr_b16 v[134:135], v58 offset:1824
    s_waitcnt lgkmcnt(12)
    v_mfma_f32_16x16x32_bf16 v[208:211], v[108:111], v[144:147], v[208:211]
    v_mfma_f32_16x16x32_bf16 v[212:215], v[108:111], v[148:151], v[212:215]
    v_mfma_f32_16x16x32_bf16 a[16:19], v[108:111], v[92:95], a[16:19]
    s_mov_b32 s63, 384
    s_add_u32 m0, s72, 129024
    s_nop 0
    buffer_load_dwordx4 v15, s[24:27], s63 offen lds
    ds_read_b64_tr_b16 v[96:97], v58 offset:64
    ds_read_b64_tr_b16 v[98:99], v58 offset:1856
    s_waitcnt lgkmcnt(12)
    v_mfma_f32_16x16x32_bf16 v[216:219], v[112:115], v[144:147], v[216:219]
    v_mfma_f32_16x16x32_bf16 v[220:223], v[112:115], v[148:151], v[220:223]
    v_mfma_f32_16x16x32_bf16 a[20:23], v[112:115], v[92:95], a[20:23]
    v_mfma_f32_16x16x32_bf16 a[40:43], v[92:95], v[148:151], a[40:43]
    ds_read_b64_tr_b16 v[100:101], v58 offset:96
    ds_read_b64_tr_b16 v[102:103], v58 offset:1888
    s_waitcnt lgkmcnt(12)
    v_mfma_f32_16x16x32_bf16 v[224:227], v[116:119], v[144:147], v[224:227]
    v_mfma_f32_16x16x32_bf16 v[228:231], v[116:119], v[148:151], v[228:231]
    v_mfma_f32_16x16x32_bf16 a[24:27], v[116:119], v[92:95], a[24:27]
    s_mov_b32 s63, 688128
    s_add_u32 m0, s73, 142336
    s_nop 0
    buffer_load_dwordx4 v16, s[28:31], s63 offen lds
    ds_read_b64_tr_b16 v[104:105], v58 offset:128
    ds_read_b64_tr_b16 v[106:107], v58 offset:1920
    s_waitcnt lgkmcnt(13)
    v_mfma_f32_16x16x32_bf16 v[232:235], v[144:147], v[120:123], v[232:235]
    v_mfma_f32_16x16x32_bf16 v[236:239], v[148:151], v[120:123], v[236:239]
    v_mfma_f32_16x16x32_bf16 a[28:31], v[92:95], v[120:123], a[28:31]
    v_mfma_f32_16x16x32_bf16 a[48:51], v[148:151], v[148:151], a[48:51]
    ds_read_b64_tr_b16 v[108:109], v58 offset:160
    ds_read_b64_tr_b16 v[110:111], v58 offset:1952
    s_waitcnt lgkmcnt(14)
    v_mfma_f32_16x16x32_bf16 v[240:243], v[144:147], v[124:127], v[240:243]
    v_mfma_f32_16x16x32_bf16 v[244:247], v[148:151], v[124:127], v[244:247]
    v_mfma_f32_16x16x32_bf16 a[32:35], v[92:95], v[124:127], a[32:35]
    s_mov_b32 s63, 688128
    s_add_u32 m0, s73, 146432
    s_nop 0
    buffer_load_dwordx4 v17, s[28:31], s63 offen lds
    ds_read_b64_tr_b16 v[112:113], v58 offset:192
    ds_read_b64_tr_b16 v[114:115], v58 offset:1984
    ds_read_b128 v[116:119], v46 offset:128
    ds_read_b128 v[120:123], v46 offset:17024
    s_waitcnt lgkmcnt(14)
    v_mfma_f32_16x16x32_bf16 v[176:179], v[128:131], v[152:155], v[176:179]
    v_mfma_f32_16x16x32_bf16 v[180:183], v[128:131], v[156:159], v[180:183]
    v_mfma_f32_16x16x32_bf16 a[0:3], v[128:131], v[92:95], a[0:3]
    s_mov_b32 s63, 688128
    s_add_u32 m0, s73, 150528
    s_nop 0
    buffer_load_dwordx4 v18, s[28:31], s63 offen lds
    ds_read_b128 v[160:163], v60 offset:0
    s_waitcnt lgkmcnt(13)
    v_mfma_f32_16x16x32_bf16 v[184:187], v[132:135], v[152:155], v[184:187]
    v_mfma_f32_16x16x32_bf16 v[188:191], v[132:135], v[156:159], v[188:191]
    v_mfma_f32_16x16x32_bf16 a[4:7], v[132:135], v[92:95], a[4:7]
    v_mfma_f32_16x16x32_bf16 a[36:39], v[92:95], v[152:155], a[36:39]
    ds_read_b128 v[164:167], v60 offset:2048
    s_waitcnt lgkmcnt(12)
    v_mfma_f32_16x16x32_bf16 v[192:195], v[96:99], v[152:155], v[192:195]
    v_mfma_f32_16x16x32_bf16 v[196:199], v[96:99], v[156:159], v[196:199]
    v_mfma_f32_16x16x32_bf16 a[8:11], v[96:99], v[92:95], a[8:11]
    s_mov_b32 s63, 688128
    s_add_u32 m0, s67, 142336
    s_mov_b64 exec, s[68:69]
    buffer_load_dwordx4 v19, s[28:31], s63 offen lds
    s_mov_b64 exec, -1
    ds_read_b64_tr_b16 v[124:125], v58 offset:7168
    ds_read_b64_tr_b16 v[126:127], v58 offset:8960
    s_waitcnt lgkmcnt(12)
    v_mfma_f32_16x16x32_bf16 v[200:203], v[100:103], v[152:155], v[200:203]
    v_mfma_f32_16x16x32_bf16 v[204:207], v[100:103], v[156:159], v[204:207]
    v_mfma_f32_16x16x32_bf16 a[12:15], v[100:103], v[92:95], a[12:15]
    v_mfma_f32_16x16x32_bf16 a[44:47], v[152:155], v[152:155], a[44:47]
    ds_read_b64_tr_b16 v[128:129], v58 offset:7200
    ds_read_b64_tr_b16 v[130:131], v58 offset:8992
    s_waitcnt lgkmcnt(12)
    v_mfma_f32_16x16x32_bf16 v[208:211], v[104:107], v[152:155], v[208:211]
    v_mfma_f32_16x16x32_bf16 v[212:215], v[104:107], v[156:159], v[212:215]
    v_mfma_f32_16x16x32_bf16 a[16:19], v[104:107], v[92:95], a[16:19]
    ds_read_b64_tr_b16 v[132:133], v58 offset:7232
    ds_read_b64_tr_b16 v[134:135], v58 offset:9024
    s_waitcnt lgkmcnt(12)
    v_mfma_f32_16x16x32_bf16 v[216:219], v[108:111], v[152:155], v[216:219]
    v_mfma_f32_16x16x32_bf16 v[220:223], v[108:111], v[156:159], v[220:223]
    v_mfma_f32_16x16x32_bf16 a[20:23], v[108:111], v[92:95], a[20:23]
    v_mfma_f32_16x16x32_bf16 a[40:43], v[92:95], v[156:159], a[40:43]
    ds_read_b64_tr_b16 v[96:97], v58 offset:7264
    ds_read_b64_tr_b16 v[98:99], v58 offset:9056
    s_waitcnt lgkmcnt(12)
    v_mfma_f32_16x16x32_bf16 v[224:227], v[112:115], v[152:155], v[224:227]
    v_mfma_f32_16x16x32_bf16 v[228:231], v[112:115], v[156:159], v[228:231]
    v_mfma_f32_16x16x32_bf16 a[24:27], v[112:115], v[92:95], a[24:27]
    ds_read_b64_tr_b16 v[100:101], v58 offset:7296
    ds_read_b64_tr_b16 v[102:103], v58 offset:9088
    s_waitcnt lgkmcnt(13)
    v_mfma_f32_16x16x32_bf16 v[232:235], v[152:155], v[116:119], v[232:235]
    v_mfma_f32_16x16x32_bf16 v[236:239], v[156:159], v[116:119], v[236:239]
    v_mfma_f32_16x16x32_bf16 a[28:31], v[92:95], v[116:119], a[28:31]
    v_mfma_f32_16x16x32_bf16 a[48:51], v[156:159], v[156:159], a[48:51]
    ds_read_b64_tr_b16 v[104:105], v58 offset:7328
    ds_read_b64_tr_b16 v[106:107], v58 offset:9120
    s_waitcnt lgkmcnt(14)
    v_mfma_f32_16x16x32_bf16 v[240:243], v[152:155], v[120:123], v[240:243]
    v_mfma_f32_16x16x32_bf16 v[244:247], v[156:159], v[120:123], v[244:247]
    v_mfma_f32_16x16x32_bf16 a[32:35], v[92:95], v[120:123], a[32:35]
    ds_read_b64_tr_b16 v[108:109], v58 offset:7360
    ds_read_b64_tr_b16 v[110:111], v58 offset:9152
    ds_read_b128 v[112:115], v46 offset:192
    ds_read_b128 v[116:119], v46 offset:17088
    s_waitcnt lgkmcnt(14)
    v_mfma_f32_16x16x32_bf16 v[176:179], v[124:127], v[160:163], v[176:179]
    v_mfma_f32_16x16x32_bf16 v[180:183], v[124:127], v[164:167], v[180:183]
    v_mfma_f32_16x16x32_bf16 a[0:3], v[124:127], v[92:95], a[0:3]
    s_waitcnt vmcnt(8)
    s_barrier
    v_add_u32 v58, 111616, v44
    v_add_u32 v59, 95232, v45
    v_add_u32 v60, 95232, v43
    ds_read_b128 v[136:139], v59 offset:0
    s_waitcnt lgkmcnt(13)
    v_mfma_f32_16x16x32_bf16 v[184:187], v[128:131], v[160:163], v[184:187]
    v_mfma_f32_16x16x32_bf16 v[188:191], v[128:131], v[164:167], v[188:191]
    v_mfma_f32_16x16x32_bf16 a[4:7], v[128:131], v[92:95], a[4:7]
    v_mfma_f32_16x16x32_bf16 a[36:39], v[92:95], v[160:163], a[36:39]
    s_mov_b32 s63, 512
    s_add_u32 m0, s72, 33792
    s_nop 0
    buffer_load_dwordx4 v12, s[24:27], s63 offen lds
    ds_read_b128 v[140:143], v59 offset:2048
    s_waitcnt lgkmcnt(12)
    v_mfma_f32_16x16x32_bf16 v[192:195], v[132:135], v[160:163], v[192:195]
    v_mfma_f32_16x16x32_bf16 v[196:199], v[132:135], v[164:167], v[196:199]
    v_mfma_f32_16x16x32_bf16 a[8:11], v[132:135], v[92:95], a[8:11]
    s_mov_b32 s63, 512
    s_add_u32 m0, s72, 34816
    s_nop 0
    buffer_load_dwordx4 v13, s[24:27], s63 offen lds
    ds_read_b64_tr_b16 v[120:121], v58 offset:0
    ds_read_b64_tr_b16 v[122:123], v58 offset:1792
    s_waitcnt lgkmcnt(12)
    v_mfma_f32_16x16x32_bf16 v[200:203], v[96:99], v[160:163], v[200:203]
    v_mfma_f32_16x16x32_bf16 v[204:207], v[96:99], v[164:167], v[204:207]
    v_mfma_f32_16x16x32_bf16 a[12:15], v[96:99], v[92:95], a[12:15]
    v_mfma_f32_16x16x32_bf16 a[44:47], v[160:163], v[160:163], a[44:47]
    ds_read_b64_tr_b16 v[124:125], v58 offset:32
    ds_read_b64_tr_b16 v[126:127], v58 offset:1824
    s_waitcnt lgkmcnt(12)
    v_mfma_f32_16x16x32_bf16 v[208:211], v[100:103], v[160:163], v[208:211]
    v_mfma_f32_16x16x32_bf16 v[212:215], v[100:103], v[164:167], v[212:215]
    v_mfma_f32_16x16x32_bf16 a[16:19], v[100:103], v[92:95], a[16:19]
    s_mov_b32 s63, 512
    s_add_u32 m0, s72, 35840
    s_nop 0
    buffer_load_dwordx4 v14, s[24:27], s63 offen lds
    ds_read_b64_tr_b16 v[128:129], v58 offset:64
    ds_read_b64_tr_b16 v[130:131], v58 offset:1856
    s_waitcnt lgkmcnt(12)
    v_mfma_f32_16x16x32_bf16 v[216:219], v[104:107], v[160:163], v[216:219]
    v_mfma_f32_16x16x32_bf16 v[220:223], v[104:107], v[164:167], v[220:223]
    v_mfma_f32_16x16x32_bf16 a[20:23], v[104:107], v[92:95], a[20:23]
    v_mfma_f32_16x16x32_bf16 a[40:43], v[92:95], v[164:167], a[40:43]
    ds_read_b64_tr_b16 v[132:133], v58 offset:96
    ds_read_b64_tr_b16 v[134:135], v58 offset:1888
    s_waitcnt lgkmcnt(12)
    v_mfma_f32_16x16x32_bf16 v[224:227], v[108:111], v[160:163], v[224:227]
    v_mfma_f32_16x16x32_bf16 v[228:231], v[108:111], v[164:167], v[228:231]
    v_mfma_f32_16x16x32_bf16 a[24:27], v[108:111], v[92:95], a[24:27]
    s_mov_b32 s63, 512
    s_add_u32 m0, s72, 36864
    s_nop 0
    buffer_load_dwordx4 v15, s[24:27], s63 offen lds
    ds_read_b64_tr_b16 v[96:97], v58 offset:128
    ds_read_b64_tr_b16 v[98:99], v58 offset:1920
    s_waitcnt lgkmcnt(13)
    v_mfma_f32_16x16x32_bf16 v[232:235], v[160:163], v[112:115], v[232:235]
    v_mfma_f32_16x16x32_bf16 v[236:239], v[164:167], v[112:115], v[236:239]
    v_mfma_f32_16x16x32_bf16 a[28:31], v[92:95], v[112:115], a[28:31]
    v_mfma_f32_16x16x32_bf16 a[48:51], v[164:167], v[164:167], a[48:51]
    ds_read_b64_tr_b16 v[100:101], v58 offset:160
    ds_read_b64_tr_b16 v[102:103], v58 offset:1952
    s_waitcnt lgkmcnt(14)
    v_mfma_f32_16x16x32_bf16 v[240:243], v[160:163], v[116:119], v[240:243]
    v_mfma_f32_16x16x32_bf16 v[244:247], v[164:167], v[116:119], v[244:247]
    v_mfma_f32_16x16x32_bf16 a[32:35], v[92:95], v[116:119], a[32:35]
    s_mov_b32 s63, 917504
    s_add_u32 m0, s73, 50176
    s_nop 0
    buffer_load_dwordx4 v16, s[28:31], s63 offen lds
    ds_read_b64_tr_b16 v[104:105], v58 offset:192
    ds_read_b64_tr_b16 v[106:107], v58 offset:1984
    ds_read_b128 v[108:111], v46 offset:256
    ds_read_b128 v[112:115], v46 offset:17152
    s_waitcnt lgkmcnt(14)
    v_mfma_f32_16x16x32_bf16 v[176:179], v[120:123], v[136:139], v[176:179]
    v_mfma_f32_16x16x32_bf16 v[180:183], v[120:123], v[140:143], v[180:183]
    v_mfma_f32_16x16x32_bf16 a[0:3], v[120:123], v[92:95], a[0:3]
    s_mov_b32 s63, 917504
    s_add_u32 m0, s73, 54272
    s_nop 0
    buffer_load_dwordx4 v17, s[28:31], s63 offen lds
    ds_read_b128 v[144:147], v60 offset:0
    s_waitcnt lgkmcnt(13)
    v_mfma_f32_16x16x32_bf16 v[184:187], v[124:127], v[136:139], v[184:187]
    v_mfma_f32_16x16x32_bf16 v[188:191], v[124:127], v[140:143], v[188:191]
    v_mfma_f32_16x16x32_bf16 a[4:7], v[124:127], v[92:95], a[4:7]
    v_mfma_f32_16x16x32_bf16 a[36:39], v[92:95], v[136:139], a[36:39]
    ds_read_b128 v[148:151], v60 offset:2048
    s_waitcnt lgkmcnt(12)
    v_mfma_f32_16x16x32_bf16 v[192:195], v[128:131], v[136:139], v[192:195]
    v_mfma_f32_16x16x32_bf16 v[196:199], v[128:131], v[140:143], v[196:199]
    v_mfma_f32_16x16x32_bf16 a[8:11], v[128:131], v[92:95], a[8:11]
    s_mov_b32 s63, 917504
    s_add_u32 m0, s73, 58368
    s_nop 0
    buffer_load_dwordx4 v18, s[28:31], s63 offen lds
    ds_read_b64_tr_b16 v[116:117], v58 offset:7168
    ds_read_b64_tr_b16 v[118:119], v58 offset:8960
    s_waitcnt lgkmcnt(12)
    v_mfma_f32_16x16x32_bf16 v[200:203], v[132:135], v[136:139], v[200:203]
    v_mfma_f32_16x16x32_bf16 v[204:207], v[132:135], v[140:143], v[204:207]
    v_mfma_f32_16x16x32_bf16 a[12:15], v[132:135], v[92:95], a[12:15]
    v_mfma_f32_16x16x32_bf16 a[44:47], v[136:139], v[136:139], a[44:47]
    ds_read_b64_tr_b16 v[120:121], v58 offset:7200
    ds_read_b64_tr_b16 v[122:123], v58 offset:8992
    s_waitcnt lgkmcnt(12)
    v_mfma_f32_16x16x32_bf16 v[208:211], v[96:99], v[136:139], v[208:211]
    v_mfma_f32_16x16x32_bf16 v[212:215], v[96:99], v[140:143], v[212:215]
    v_mfma_f32_16x16x32_bf16 a[16:19], v[96:99], v[92:95], a[16:19]
    s_mov_b32 s63, 917504
    s_add_u32 m0, s67, 50176
    s_mov_b64 exec, s[68:69]
    buffer_load_dwordx4 v19, s[28:31], s63 offen lds
    s_mov_b64 exec, -1
    ds_read_b64_tr_b16 v[124:125], v58 offset:7232
    ds_read_b64_tr_b16 v[126:127], v58 offset:9024
    s_waitcnt lgkmcnt(12)
    v_mfma_f32_16x16x32_bf16 v[216:219], v[100:103], v[136:139], v[216:219]
    v_mfma_f32_16x16x32_bf16 v[220:223], v[100:103], v[140:143], v[220:223]
    v_mfma_f32_16x16x32_bf16 a[20:23], v[100:103], v[92:95], a[20:23]
    v_mfma_f32_16x16x32_bf16 a[40:43], v[92:95], v[140:143], a[40:43]
    ds_read_b64_tr_b16 v[128:129], v58 offset:7264
    ds_read_b64_tr_b16 v[130:131], v58 offset:9056
    s_waitcnt lgkmcnt(12)
    v_mfma_f32_16x16x32_bf16 v[224:227], v[104:107], v[136:139], v[224:227]
    v_mfma_f32_16x16x32_bf16 v[228:231], v[104:107], v[140:143], v[228:231]
    v_mfma_f32_16x16x32_bf16 a[24:27], v[104:107], v[92:95], a[24:27]
    ds_read_b64_tr_b16 v[132:133], v58 offset:7296
    ds_read_b64_tr_b16 v[134:135], v58 offset:9088
    s_waitcnt lgkmcnt(13)
    v_mfma_f32_16x16x32_bf16 v[232:235], v[136:139], v[108:111], v[232:235]
    v_mfma_f32_16x16x32_bf16 v[236:239], v[140:143], v[108:111], v[236:239]
    v_mfma_f32_16x16x32_bf16 a[28:31], v[92:95], v[108:111], a[28:31]
    v_mfma_f32_16x16x32_bf16 a[48:51], v[140:143], v[140:143], a[48:51]
    ds_read_b64_tr_b16 v[96:97], v58 offset:7328
    ds_read_b64_tr_b16 v[98:99], v58 offset:9120
    s_waitcnt lgkmcnt(14)
    v_mfma_f32_16x16x32_bf16 v[240:243], v[136:139], v[112:115], v[240:243]
    v_mfma_f32_16x16x32_bf16 v[244:247], v[140:143], v[112:115], v[244:247]
    v_mfma_f32_16x16x32_bf16 a[32:35], v[92:95], v[112:115], a[32:35]
    ds_read_b64_tr_b16 v[100:101], v58 offset:7360
    ds_read_b64_tr_b16 v[102:103], v58 offset:9152
    ds_read_b128 v[104:107], v46 offset:320
    ds_read_b128 v[108:111], v46 offset:17216
    s_waitcnt lgkmcnt(14)
    v_mfma_f32_16x16x32_bf16 v[176:179], v[116:119], v[144:147], v[176:179]
    v_mfma_f32_16x16x32_bf16 v[180:183], v[116:119], v[148:151], v[180:183]
    v_mfma_f32_16x16x32_bf16 a[0:3], v[116:119], v[92:95], a[0:3]
    s_waitcnt vmcnt(8)
    s_barrier
    v_add_u32 v58, 142336, v44
    v_add_u32 v59, 125952, v45
    v_add_u32 v60, 125952, v43
    ds_read_b128 v[152:155], v59 offset:0
    s_waitcnt lgkmcnt(13)
    v_mfma_f32_16x16x32_bf16 v[184:187], v[120:123], v[144:147], v[184:187]
    v_mfma_f32_16x16x32_bf16 v[188:191], v[120:123], v[148:151], v[188:191]
    v_mfma_f32_16x16x32_bf16 a[4:7], v[120:123], v[92:95], a[4:7]
    v_mfma_f32_16x16x32_bf16 a[36:39], v[92:95], v[144:147], a[36:39]
    s_mov_b32 s63, 640
    s_add_u32 m0, s72, 64512
    s_nop 0
    buffer_load_dwordx4 v12, s[24:27], s63 offen lds
    ds_read_b128 v[156:159], v59 offset:2048
    s_waitcnt lgkmcnt(12)
    v_mfma_f32_16x16x32_bf16 v[192:195], v[124:127], v[144:147], v[192:195]
    v_mfma_f32_16x16x32_bf16 v[196:199], v[124:127], v[148:151], v[196:199]
    v_mfma_f32_16x16x32_bf16 a[8:11], v[124:127], v[92:95], a[8:11]
    s_mov_b32 s63, 640
    s_add_u32 m0, s72, 65536
    s_nop 0
    buffer_load_dwordx4 v13, s[24:27], s63 offen lds
    ds_read_b64_tr_b16 v[112:113], v58 offset:0
    ds_read_b64_tr_b16 v[114:115], v58 offset:1792
    s_waitcnt lgkmcnt(12)
    v_mfma_f32_16x16x32_bf16 v[200:203], v[128:131], v[144:147], v[200:203]
    v_mfma_f32_16x16x32_bf16 v[204:207], v[128:131], v[148:151], v[204:207]
    v_mfma_f32_16x16x32_bf16 a[12:15], v[128:131], v[92:95], a[12:15]
    v_mfma_f32_16x16x32_bf16 a[44:47], v[144:147], v[144:147], a[44:47]
    ds_read_b64_tr_b16 v[116:117], v58 offset:32
    ds_read_b64_tr_b16 v[118:119], v58 offset:1824
    s_waitcnt lgkmcnt(12)
    v_mfma_f32_16x16x32_bf16 v[208:211], v[132:135], v[144:147], v[208:211]
    v_mfma_f32_16x16x32_bf16 v[212:215], v[132:135], v[148:151], v[212:215]
    v_mfma_f32_16x16x32_bf16 a[16:19], v[132:135], v[92:95], a[16:19]
    s_mov_b32 s63, 640
    s_add_u32 m0, s72, 66560
    s_nop 0
    buffer_load_dwordx4 v14, s[24:27], s63 offen lds
    ds_read_b64_tr_b16 v[120:121], v58 offset:64
    ds_read_b64_tr_b16 v[122:123], v58 offset:1856
    s_waitcnt lgkmcnt(12)
    v_mfma_f32_16x16x32_bf16 v[216:219], v[96:99], v[144:147], v[216:219]
    v_mfma_f32_16x16x32_bf16 v[220:223], v[96:99], v[148:151], v[220:223]
    v_mfma_f32_16x16x32_bf16 a[20:23], v[96:99], v[92:95], a[20:23]
    v_mfma_f32_16x16x32_bf16 a[40:43], v[92:95], v[148:151], a[40:43]
    ds_read_b64_tr_b16 v[124:125], v58 offset:96
    ds_read_b64_tr_b16 v[126:127], v58 offset:1888
    s_waitcnt lgkmcnt(12)
    v_mfma_f32_16x16x32_bf16 v[224:227], v[100:103], v[144:147], v[224:227]
    v_mfma_f32_16x16x32_bf16 v[228:231], v[100:103], v[148:151], v[228:231]
    v_mfma_f32_16x16x32_bf16 a[24:27], v[100:103], v[92:95], a[24:27]
    s_mov_b32 s63, 640
    s_add_u32 m0, s72, 67584
    s_nop 0
    buffer_load_dwordx4 v15, s[24:27], s63 offen lds
    ds_read_b64_tr_b16 v[128:129], v58 offset:128
    ds_read_b64_tr_b16 v[130:131], v58 offset:1920
    s_waitcnt lgkmcnt(13)
    v_mfma_f32_16x16x32_bf16 v[232:235], v[144:147], v[104:107], v[232:235]
    v_mfma_f32_16x16x32_bf16 v[236:239], v[148:151], v[104:107], v[236:239]
    v_mfma_f32_16x16x32_bf16 a[28:31], v[92:95], v[104:107], a[28:31]
    v_mfma_f32_16x16x32_bf16 a[48:51], v[148:151], v[148:151], a[48:51]
    ds_read_b64_tr_b16 v[132:133], v58 offset:160
    ds_read_b64_tr_b16 v[134:135], v58 offset:1952
    s_waitcnt lgkmcnt(14)
    v_mfma_f32_16x16x32_bf16 v[240:243], v[144:147], v[108:111], v[240:243]
    v_mfma_f32_16x16x32_bf16 v[244:247], v[148:151], v[108:111], v[244:247]
    v_mfma_f32_16x16x32_bf16 a[32:35], v[92:95], v[108:111], a[32:35]
    s_mov_b32 s63, 1146880
    s_add_u32 m0, s73, 80896
    s_nop 0
    buffer_load_dwordx4 v16, s[28:31], s63 offen lds
    ds_read_b64_tr_b16 v[96:97], v58 offset:192
    ds_read_b64_tr_b16 v[98:99], v58 offset:1984
    ds_read_b128 v[100:103], v46 offset:384
    ds_read_b128 v[104:107], v46 offset:17280
    s_waitcnt lgkmcnt(14)
    v_mfma_f32_16x16x32_bf16 v[176:179], v[112:115], v[152:155], v[176:179]
    v_mfma_f32_16x16x32_bf16 v[180:183], v[112:115], v[156:159], v[180:183]
    v_mfma_f32_16x16x32_bf16 a[0:3], v[112:115], v[92:95], a[0:3]
    s_mov_b32 s63, 1146880
    s_add_u32 m0, s73, 84992
    s_nop 0
    buffer_load_dwordx4 v17, s[28:31], s63 offen lds
    ds_read_b128 v[160:163], v60 offset:0
    s_waitcnt lgkmcnt(13)
    v_mfma_f32_16x16x32_bf16 v[184:187], v[116:119], v[152:155], v[184:187]
    v_mfma_f32_16x16x32_bf16 v[188:191], v[116:119], v[156:159], v[188:191]
    v_mfma_f32_16x16x32_bf16 a[4:7], v[116:119], v[92:95], a[4:7]
    v_mfma_f32_16x16x32_bf16 a[36:39], v[92:95], v[152:155], a[36:39]
    ds_read_b128 v[164:167], v60 offset:2048
    s_waitcnt lgkmcnt(12)
    v_mfma_f32_16x16x32_bf16 v[192:195], v[120:123], v[152:155], v[192:195]
    v_mfma_f32_16x16x32_bf16 v[196:199], v[120:123], v[156:159], v[196:199]
    v_mfma_f32_16x16x32_bf16 a[8:11], v[120:123], v[92:95], a[8:11]
    s_mov_b32 s63, 1146880
    s_add_u32 m0, s73, 89088
    s_nop 0
    buffer_load_dwordx4 v18, s[28:31], s63 offen lds
    ds_read_b64_tr_b16 v[108:109], v58 offset:7168
    ds_read_b64_tr_b16 v[110:111], v58 offset:8960
    s_waitcnt lgkmcnt(12)
    v_mfma_f32_16x16x32_bf16 v[200:203], v[124:127], v[152:155], v[200:203]
    v_mfma_f32_16x16x32_bf16 v[204:207], v[124:127], v[156:159], v[204:207]
    v_mfma_f32_16x16x32_bf16 a[12:15], v[124:127], v[92:95], a[12:15]
    v_mfma_f32_16x16x32_bf16 a[44:47], v[152:155], v[152:155], a[44:47]
    ds_read_b64_tr_b16 v[112:113], v58 offset:7200
    ds_read_b64_tr_b16 v[114:115], v58 offset:8992
    s_waitcnt lgkmcnt(12)
    v_mfma_f32_16x16x32_bf16 v[208:211], v[128:131], v[152:155], v[208:211]
    v_mfma_f32_16x16x32_bf16 v[212:215], v[128:131], v[156:159], v[212:215]
    v_mfma_f32_16x16x32_bf16 a[16:19], v[128:131], v[92:95], a[16:19]
    s_mov_b32 s63, 1146880
    s_add_u32 m0, s67, 80896
    s_mov_b64 exec, s[68:69]
    buffer_load_dwordx4 v19, s[28:31], s63 offen lds
    s_mov_b64 exec, -1
    ds_read_b64_tr_b16 v[116:117], v58 offset:7232
    ds_read_b64_tr_b16 v[118:119], v58 offset:9024
    s_waitcnt lgkmcnt(12)
    v_mfma_f32_16x16x32_bf16 v[216:219], v[132:135], v[152:155], v[216:219]
    v_mfma_f32_16x16x32_bf16 v[220:223], v[132:135], v[156:159], v[220:223]
    v_mfma_f32_16x16x32_bf16 a[20:23], v[132:135], v[92:95], a[20:23]
    v_mfma_f32_16x16x32_bf16 a[40:43], v[92:95], v[156:159], a[40:43]
    ds_read_b64_tr_b16 v[120:121], v58 offset:7264
    ds_read_b64_tr_b16 v[122:123], v58 offset:9056
    s_waitcnt lgkmcnt(12)
    v_mfma_f32_16x16x32_bf16 v[224:227], v[96:99], v[152:155], v[224:227]
    v_mfma_f32_16x16x32_bf16 v[228:231], v[96:99], v[156:159], v[228:231]
    v_mfma_f32_16x16x32_bf16 a[24:27], v[96:99], v[92:95], a[24:27]
    ds_read_b64_tr_b16 v[124:125], v58 offset:7296
    ds_read_b64_tr_b16 v[126:127], v58 offset:9088
    s_waitcnt lgkmcnt(13)
    v_mfma_f32_16x16x32_bf16 v[232:235], v[152:155], v[100:103], v[232:235]
    v_mfma_f32_16x16x32_bf16 v[236:239], v[156:159], v[100:103], v[236:239]
    v_mfma_f32_16x16x32_bf16 a[28:31], v[92:95], v[100:103], a[28:31]
    v_mfma_f32_16x16x32_bf16 a[48:51], v[156:159], v[156:159], a[48:51]
    ds_read_b64_tr_b16 v[128:129], v58 offset:7328
    ds_read_b64_tr_b16 v[130:131], v58 offset:9120
    s_waitcnt lgkmcnt(14)
    v_mfma_f32_16x16x32_bf16 v[240:243], v[152:155], v[104:107], v[240:243]
    v_mfma_f32_16x16x32_bf16 v[244:247], v[156:159], v[104:107], v[244:247]
    v_mfma_f32_16x16x32_bf16 a[32:35], v[92:95], v[104:107], a[32:35]
    ds_read_b64_tr_b16 v[132:133], v58 offset:7360
    ds_read_b64_tr_b16 v[134:135], v58 offset:9152
    ds_read_b128 v[96:99], v46 offset:448
    ds_read_b128 v[100:103], v46 offset:17344
    s_waitcnt lgkmcnt(14)
    v_mfma_f32_16x16x32_bf16 v[176:179], v[108:111], v[160:163], v[176:179]
    v_mfma_f32_16x16x32_bf16 v[180:183], v[108:111], v[164:167], v[180:183]
    v_mfma_f32_16x16x32_bf16 a[0:3], v[108:111], v[92:95], a[0:3]
    s_waitcnt vmcnt(8)
    s_barrier
    v_add_u32 v58, 50176, v44
    v_add_u32 v59, 33792, v45
    v_add_u32 v60, 33792, v43
    ds_read_b128 v[136:139], v59 offset:0
    s_waitcnt lgkmcnt(13)
    v_mfma_f32_16x16x32_bf16 v[184:187], v[112:115], v[160:163], v[184:187]
    v_mfma_f32_16x16x32_bf16 v[188:191], v[112:115], v[164:167], v[188:191]
    v_mfma_f32_16x16x32_bf16 a[4:7], v[112:115], v[92:95], a[4:7]
    v_mfma_f32_16x16x32_bf16 a[36:39], v[92:95], v[160:163], a[36:39]
    s_mov_b32 s63, 768
    s_add_u32 m0, s72, 95232
    s_nop 0
    buffer_load_dwordx4 v12, s[24:27], s63 offen lds
    ds_read_b128 v[140:143], v59 offset:2048
    s_waitcnt lgkmcnt(12)
    v_mfma_f32_16x16x32_bf16 v[192:195], v[116:119], v[160:163], v[192:195]
    v_mfma_f32_16x16x32_bf16 v[196:199], v[116:119], v[164:167], v[196:199]
    v_mfma_f32_16x16x32_bf16 a[8:11], v[116:119], v[92:95], a[8:11]
    s_mov_b32 s63, 768
    s_add_u32 m0, s72, 96256
    s_nop 0
    buffer_load_dwordx4 v13, s[24:27], s63 offen lds
    ds_read_b64_tr_b16 v[104:105], v58 offset:0
    ds_read_b64_tr_b16 v[106:107], v58 offset:1792
    s_waitcnt lgkmcnt(12)
    v_mfma_f32_16x16x32_bf16 v[200:203], v[120:123], v[160:163], v[200:203]
    v_mfma_f32_16x16x32_bf16 v[204:207], v[120:123], v[164:167], v[204:207]
    v_mfma_f32_16x16x32_bf16 a[12:15], v[120:123], v[92:95], a[12:15]
    v_mfma_f32_16x16x32_bf16 a[44:47], v[160:163], v[160:163], a[44:47]
    ds_read_b64_tr_b16 v[108:109], v58 offset:32
    ds_read_b64_tr_b16 v[110:111], v58 offset:1824
    s_waitcnt lgkmcnt(12)
    v_mfma_f32_16x16x32_bf16 v[208:211], v[124:127], v[160:163], v[208:211]
    v_mfma_f32_16x16x32_bf16 v[212:215], v[124:127], v[164:167], v[212:215]
    v_mfma_f32_16x16x32_bf16 a[16:19], v[124:127], v[92:95], a[16:19]
    s_mov_b32 s63, 768
    s_add_u32 m0, s72, 97280
    s_nop 0
    buffer_load_dwordx4 v14, s[24:27], s63 offen lds
    ds_read_b64_tr_b16 v[112:113], v58 offset:64
    ds_read_b64_tr_b16 v[114:115], v58 offset:1856
    s_waitcnt lgkmcnt(12)
    v_mfma_f32_16x16x32_bf16 v[216:219], v[128:131], v[160:163], v[216:219]
    v_mfma_f32_16x16x32_bf16 v[220:223], v[128:131], v[164:167], v[220:223]
    v_mfma_f32_16x16x32_bf16 a[20:23], v[128:131], v[92:95], a[20:23]
    v_mfma_f32_16x16x32_bf16 a[40:43], v[92:95], v[164:167], a[40:43]
    ds_read_b64_tr_b16 v[116:117], v58 offset:96
    ds_read_b64_tr_b16 v[118:119], v58 offset:1888
    s_waitcnt lgkmcnt(12)
    v_mfma_f32_16x16x32_bf16 v[224:227], v[132:135], v[160:163], v[224:227]
    v_mfma_f32_16x16x32_bf16 v[228:231], v[132:135], v[164:167], v[228:231]
    v_mfma_f32_16x16x32_bf16 a[24:27], v[132:135], v[92:95], a[24:27]
    s_mov_b32 s63, 768
    s_add_u32 m0, s72, 98304
    s_nop 0
    buffer_load_dwordx4 v15, s[24:27], s63 offen lds
    ds_read_b64_tr_b16 v[120:121], v58 offset:128
    ds_read_b64_tr_b16 v[122:123], v58 offset:1920
    s_waitcnt lgkmcnt(13)
    v_mfma_f32_16x16x32_bf16 v[232:235], v[160:163], v[96:99], v[232:235]
    v_mfma_f32_16x16x32_bf16 v[236:239], v[164:167], v[96:99], v[236:239]
    v_mfma_f32_16x16x32_bf16 a[28:31], v[92:95], v[96:99], a[28:31]
    v_mfma_f32_16x16x32_bf16 a[48:51], v[164:167], v[164:167], a[48:51]
    ds_read_b64_tr_b16 v[124:125], v58 offset:160
    ds_read_b64_tr_b16 v[126:127], v58 offset:1952
    s_waitcnt lgkmcnt(14)
    v_mfma_f32_16x16x32_bf16 v[240:243], v[160:163], v[100:103], v[240:243]
    v_mfma_f32_16x16x32_bf16 v[244:247], v[164:167], v[100:103], v[244:247]
    v_mfma_f32_16x16x32_bf16 a[32:35], v[92:95], v[100:103], a[32:35]
    s_mov_b32 s63, 1376256
    s_add_u32 m0, s73, 111616
    s_nop 0
    buffer_load_dwordx4 v16, s[28:31], s63 offen lds
    ds_read_b64_tr_b16 v[128:129], v58 offset:192
    ds_read_b64_tr_b16 v[130:131], v58 offset:1984
    ds_read_b128 v[132:135], v46 offset:512
    ds_read_b128 v[96:99], v46 offset:17408
    s_waitcnt lgkmcnt(14)
    v_mfma_f32_16x16x32_bf16 v[176:179], v[104:107], v[136:139], v[176:179]
    v_mfma_f32_16x16x32_bf16 v[180:183], v[104:107], v[140:143], v[180:183]
    v_mfma_f32_16x16x32_bf16 a[0:3], v[104:107], v[92:95], a[0:3]
    s_mov_b32 s63, 1376256
    s_add_u32 m0, s73, 115712
    s_nop 0
    buffer_load_dwordx4 v17, s[28:31], s63 offen lds
    ds_read_b128 v[144:147], v60 offset:0
    s_waitcnt lgkmcnt(13)
    v_mfma_f32_16x16x32_bf16 v[184:187], v[108:111], v[136:139], v[184:187]
    v_mfma_f32_16x16x32_bf16 v[188:191], v[108:111], v[140:143], v[188:191]
    v_mfma_f32_16x16x32_bf16 a[4:7], v[108:111], v[92:95], a[4:7]
    v_mfma_f32_16x16x32_bf16 a[36:39], v[92:95], v[136:139], a[36:39]
    ds_read_b128 v[148:151], v60 offset:2048
    s_waitcnt lgkmcnt(12)
    v_mfma_f32_16x16x32_bf16 v[192:195], v[112:115], v[136:139], v[192:195]
    v_mfma_f32_16x16x32_bf16 v[196:199], v[112:115], v[140:143], v[196:199]
    v_mfma_f32_16x16x32_bf16 a[8:11], v[112:115], v[92:95], a[8:11]
    s_mov_b32 s63, 1376256
    s_add_u32 m0, s73, 119808
    s_nop 0
    buffer_load_dwordx4 v18, s[28:31], s63 offen lds
    ds_read_b64_tr_b16 v[100:101], v58 offset:7168
    ds_read_b64_tr_b16 v[102:103], v58 offset:8960
    s_waitcnt lgkmcnt(12)
    v_mfma_f32_16x16x32_bf16 v[200:203], v[116:119], v[136:139], v[200:203]
    v_mfma_f32_16x16x32_bf16 v[204:207], v[116:119], v[140:143], v[204:207]
    v_mfma_f32_16x16x32_bf16 a[12:15], v[116:119], v[92:95], a[12:15]
    v_mfma_f32_16x16x32_bf16 a[44:47], v[136:139], v[136:139], a[44:47]
    ds_read_b64_tr_b16 v[104:105], v58 offset:7200
    ds_read_b64_tr_b16 v[106:107], v58 offset:8992
    s_waitcnt lgkmcnt(12)
    v_mfma_f32_16x16x32_bf16 v[208:211], v[120:123], v[136:139], v[208:211]
    v_mfma_f32_16x16x32_bf16 v[212:215], v[120:123], v[140:143], v[212:215]
    v_mfma_f32_16x16x32_bf16 a[16:19], v[120:123], v[92:95], a[16:19]
    s_mov_b32 s63, 1376256
    s_add_u32 m0, s67, 111616
    s_mov_b64 exec, s[68:69]
    buffer_load_dwordx4 v19, s[28:31], s63 offen lds
    s_mov_b64 exec, -1
    ds_read_b64_tr_b16 v[108:109], v58 offset:7232
    ds_read_b64_tr_b16 v[110:111], v58 offset:9024
    s_waitcnt lgkmcnt(12)
    v_mfma_f32_16x16x32_bf16 v[216:219], v[124:127], v[136:139], v[216:219]
    v_mfma_f32_16x16x32_bf16 v[220:223], v[124:127], v[140:143], v[220:223]
    v_mfma_f32_16x16x32_bf16 a[20:23], v[124:127], v[92:95], a[20:23]
    v_mfma_f32_16x16x32_bf16 a[40:43], v[92:95], v[140:143], a[40:43]
    ds_read_b64_tr_b16 v[112:113], v58 offset:7264
    ds_read_b64_tr_b16 v[114:115], v58 offset:9056
    s_waitcnt lgkmcnt(12)
    v_mfma_f32_16x16x32_bf16 v[224:227], v[128:131], v[136:139], v[224:227]
    v_mfma_f32_16x16x32_bf16 v[228:231], v[128:131], v[140:143], v[228:231]
    v_mfma_f32_16x16x32_bf16 a[24:27], v[128:131], v[92:95], a[24:27]
    ds_read_b64_tr_b16 v[116:117], v58 offset:7296
    ds_read_b64_tr_b16 v[118:119], v58 offset:9088
    s_waitcnt lgkmcnt(13)
    v_mfma_f32_16x16x32_bf16 v[232:235], v[136:139], v[132:135], v[232:235]
    v_mfma_f32_16x16x32_bf16 v[236:239], v[140:143], v[132:135], v[236:239]
    v_mfma_f32_16x16x32_bf16 a[28:31], v[92:95], v[132:135], a[28:31]
    v_mfma_f32_16x16x32_bf16 a[48:51], v[140:143], v[140:143], a[48:51]
    ds_read_b64_tr_b16 v[120:121], v58 offset:7328
    ds_read_b64_tr_b16 v[122:123], v58 offset:9120
    s_waitcnt lgkmcnt(14)
    v_mfma_f32_16x16x32_bf16 v[240:243], v[136:139], v[96:99], v[240:243]
    v_mfma_f32_16x16x32_bf16 v[244:247], v[140:143], v[96:99], v[244:247]
    v_mfma_f32_16x16x32_bf16 a[32:35], v[92:95], v[96:99], a[32:35]
    ds_read_b64_tr_b16 v[124:125], v58 offset:7360
    ds_read_b64_tr_b16 v[126:127], v58 offset:9152
    ds_read_b128 v[128:131], v46 offset:576
    ds_read_b128 v[132:135], v46 offset:17472
    s_waitcnt lgkmcnt(14)
    v_mfma_f32_16x16x32_bf16 v[176:179], v[100:103], v[144:147], v[176:179]
    v_mfma_f32_16x16x32_bf16 v[180:183], v[100:103], v[148:151], v[180:183]
    v_mfma_f32_16x16x32_bf16 a[0:3], v[100:103], v[92:95], a[0:3]
    s_waitcnt vmcnt(8)
    s_barrier
    v_add_u32 v58, 80896, v44
    v_add_u32 v59, 64512, v45
    v_add_u32 v60, 64512, v43
    ds_read_b128 v[152:155], v59 offset:0
    s_waitcnt lgkmcnt(13)
    v_mfma_f32_16x16x32_bf16 v[184:187], v[104:107], v[144:147], v[184:187]
    v_mfma_f32_16x16x32_bf16 v[188:191], v[104:107], v[148:151], v[188:191]
    v_mfma_f32_16x16x32_bf16 a[4:7], v[104:107], v[92:95], a[4:7]
    v_mfma_f32_16x16x32_bf16 a[36:39], v[92:95], v[144:147], a[36:39]
    s_mov_b32 s63, 896
    s_add_u32 m0, s72, 125952
    s_nop 0
    buffer_load_dwordx4 v12, s[24:27], s63 offen lds
    ds_read_b128 v[156:159], v59 offset:2048
    s_waitcnt lgkmcnt(12)
    v_mfma_f32_16x16x32_bf16 v[192:195], v[108:111], v[144:147], v[192:195]
    v_mfma_f32_16x16x32_bf16 v[196:199], v[108:111], v[148:151], v[196:199]
    v_mfma_f32_16x16x32_bf16 a[8:11], v[108:111], v[92:95], a[8:11]
    s_mov_b32 s63, 896
    s_add_u32 m0, s72, 126976
    s_nop 0
    buffer_load_dwordx4 v13, s[24:27], s63 offen lds
    ds_read_b64_tr_b16 v[96:97], v58 offset:0
    ds_read_b64_tr_b16 v[98:99], v58 offset:1792
    s_waitcnt lgkmcnt(12)
    v_mfma_f32_16x16x32_bf16 v[200:203], v[112:115], v[144:147], v[200:203]
    v_mfma_f32_16x16x32_bf16 v[204:207], v[112:115], v[148:151], v[204:207]
    v_mfma_f32_16x16x32_bf16 a[12:15], v[112:115], v[92:95], a[12:15]
    v_mfma_f32_16x16x32_bf16 a[44:47], v[144:147], v[144:147], a[44:47]
    ds_read_b64_tr_b16 v[100:101], v58 offset:32
    ds_read_b64_tr_b16 v[102:103], v58 offset:1824
    s_waitcnt lgkmcnt(12)
    v_mfma_f32_16x16x32_bf16 v[208:211], v[116:119], v[144:147], v[208:211]
    v_mfma_f32_16x16x32_bf16 v[212:215], v[116:119], v[148:151], v[212:215]
    v_mfma_f32_16x16x32_bf16 a[16:19], v[116:119], v[92:95], a[16:19]
    s_mov_b32 s63, 896
    s_add_u32 m0, s72, 128000
    s_nop 0
    buffer_load_dwordx4 v14, s[24:27], s63 offen lds
    ds_read_b64_tr_b16 v[104:105], v58 offset:64
    ds_read_b64_tr_b16 v[106:107], v58 offset:1856
    s_waitcnt lgkmcnt(12)
    v_mfma_f32_16x16x32_bf16 v[216:219], v[120:123], v[144:147], v[216:219]
    v_mfma_f32_16x16x32_bf16 v[220:223], v[120:123], v[148:151], v[220:223]
    v_mfma_f32_16x16x32_bf16 a[20:23], v[120:123], v[92:95], a[20:23]
    v_mfma_f32_16x16x32_bf16 a[40:43], v[92:95], v[148:151], a[40:43]
    ds_read_b64_tr_b16 v[108:109], v58 offset:96
    ds_read_b64_tr_b16 v[110:111], v58 offset:1888
    s_waitcnt lgkmcnt(12)
    v_mfma_f32_16x16x32_bf16 v[224:227], v[124:127], v[144:147], v[224:227]
    v_mfma_f32_16x16x32_bf16 v[228:231], v[124:127], v[148:151], v[228:231]
    v_mfma_f32_16x16x32_bf16 a[24:27], v[124:127], v[92:95], a[24:27]
    s_mov_b32 s63, 896
    s_add_u32 m0, s72, 129024
    s_nop 0
    buffer_load_dwordx4 v15, s[24:27], s63 offen lds
    ds_read_b64_tr_b16 v[112:113], v58 offset:128
    ds_read_b64_tr_b16 v[114:115], v58 offset:1920
    s_waitcnt lgkmcnt(13)
    v_mfma_f32_16x16x32_bf16 v[232:235], v[144:147], v[128:131], v[232:235]
    v_mfma_f32_16x16x32_bf16 v[236:239], v[148:151], v[128:131], v[236:239]
    v_mfma_f32_16x16x32_bf16 a[28:31], v[92:95], v[128:131], a[28:31]
    v_mfma_f32_16x16x32_bf16 a[48:51], v[148:151], v[148:151], a[48:51]
    ds_read_b64_tr_b16 v[116:117], v58 offset:160
    ds_read_b64_tr_b16 v[118:119], v58 offset:1952
    s_waitcnt lgkmcnt(14)
    v_mfma_f32_16x16x32_bf16 v[240:243], v[144:147], v[132:135], v[240:243]
    v_mfma_f32_16x16x32_bf16 v[244:247], v[148:151], v[132:135], v[244:247]
    v_mfma_f32_16x16x32_bf16 a[32:35], v[92:95], v[132:135], a[32:35]
    s_mov_b32 s63, 1605632
    s_add_u32 m0, s73, 142336
    s_nop 0
    buffer_load_dwordx4 v16, s[28:31], s63 offen lds
    ds_read_b64_tr_b16 v[120:121], v58 offset:192
    ds_read_b64_tr_b16 v[122:123], v58 offset:1984
    ds_read_b128 v[124:127], v46 offset:640
    ds_read_b128 v[128:131], v46 offset:17536
    s_waitcnt lgkmcnt(14)
    v_mfma_f32_16x16x32_bf16 v[176:179], v[96:99], v[152:155], v[176:179]
    v_mfma_f32_16x16x32_bf16 v[180:183], v[96:99], v[156:159], v[180:183]
    v_mfma_f32_16x16x32_bf16 a[0:3], v[96:99], v[92:95], a[0:3]
    s_mov_b32 s63, 1605632
    s_add_u32 m0, s73, 146432
    s_nop 0
    buffer_load_dwordx4 v17, s[28:31], s63 offen lds
    ds_read_b128 v[160:163], v60 offset:0
    s_waitcnt lgkmcnt(13)
    v_mfma_f32_16x16x32_bf16 v[184:187], v[100:103], v[152:155], v[184:187]
    v_mfma_f32_16x16x32_bf16 v[188:191], v[100:103], v[156:159], v[188:191]
    v_mfma_f32_16x16x32_bf16 a[4:7], v[100:103], v[92:95], a[4:7]
    v_mfma_f32_16x16x32_bf16 a[36:39], v[92:95], v[152:155], a[36:39]
    ds_read_b128 v[164:167], v60 offset:2048
    s_waitcnt lgkmcnt(12)
    v_mfma_f32_16x16x32_bf16 v[192:195], v[104:107], v[152:155], v[192:195]
    v_mfma_f32_16x16x32_bf16 v[196:199], v[104:107], v[156:159], v[196:199]
    v_mfma_f32_16x16x32_bf16 a[8:11], v[104:107], v[92:95], a[8:11]
    s_mov_b32 s63, 1605632
    s_add_u32 m0, s73, 150528
    s_nop 0
    buffer_load_dwordx4 v18, s[28:31], s63 offen lds
    ds_read_b64_tr_b16 v[132:133], v58 offset:7168
    ds_read_b64_tr_b16 v[134:135], v58 offset:8960
    s_waitcnt lgkmcnt(12)
    v_mfma_f32_16x16x32_bf16 v[200:203], v[108:111], v[152:155], v[200:203]
    v_mfma_f32_16x16x32_bf16 v[204:207], v[108:111], v[156:159], v[204:207]
    v_mfma_f32_16x16x32_bf16 a[12:15], v[108:111], v[92:95], a[12:15]
    v_mfma_f32_16x16x32_bf16 a[44:47], v[152:155], v[152:155], a[44:47]
    ds_read_b64_tr_b16 v[96:97], v58 offset:7200
    ds_read_b64_tr_b16 v[98:99], v58 offset:8992
    s_waitcnt lgkmcnt(12)
    v_mfma_f32_16x16x32_bf16 v[208:211], v[112:115], v[152:155], v[208:211]
    v_mfma_f32_16x16x32_bf16 v[212:215], v[112:115], v[156:159], v[212:215]
    v_mfma_f32_16x16x32_bf16 a[16:19], v[112:115], v[92:95], a[16:19]
    s_mov_b32 s63, 1605632
    s_add_u32 m0, s67, 142336
    s_mov_b64 exec, s[68:69]
    buffer_load_dwordx4 v19, s[28:31], s63 offen lds
    s_mov_b64 exec, -1
    ds_read_b64_tr_b16 v[100:101], v58 offset:7232
    ds_read_b64_tr_b16 v[102:103], v58 offset:9024
    s_waitcnt lgkmcnt(12)
    v_mfma_f32_16x16x32_bf16 v[216:219], v[116:119], v[152:155], v[216:219]
    v_mfma_f32_16x16x32_bf16 v[220:223], v[116:119], v[156:159], v[220:223]
    v_mfma_f32_16x16x32_bf16 a[20:23], v[116:119], v[92:95], a[20:23]
    v_mfma_f32_16x16x32_bf16 a[40:43], v[92:95], v[156:159], a[40:43]
    ds_read_b64_tr_b16 v[104:105], v58 offset:7264
    ds_read_b64_tr_b16 v[106:107], v58 offset:9056
    s_waitcnt lgkmcnt(12)
    v_mfma_f32_16x16x32_bf16 v[224:227], v[120:123], v[152:155], v[224:227]
    v_mfma_f32_16x16x32_bf16 v[228:231], v[120:123], v[156:159], v[228:231]
    v_mfma_f32_16x16x32_bf16 a[24:27], v[120:123], v[92:95], a[24:27]
    ds_read_b64_tr_b16 v[108:109], v58 offset:7296
    ds_read_b64_tr_b16 v[110:111], v58 offset:9088
    s_waitcnt lgkmcnt(13)
    v_mfma_f32_16x16x32_bf16 v[232:235], v[152:155], v[124:127], v[232:235]
    v_mfma_f32_16x16x32_bf16 v[236:239], v[156:159], v[124:127], v[236:239]
    v_mfma_f32_16x16x32_bf16 a[28:31], v[92:95], v[124:127], a[28:31]
    v_mfma_f32_16x16x32_bf16 a[48:51], v[156:159], v[156:159], a[48:51]
    ds_read_b64_tr_b16 v[112:113], v58 offset:7328
    ds_read_b64_tr_b16 v[114:115], v58 offset:9120
    s_waitcnt lgkmcnt(14)
    v_mfma_f32_16x16x32_bf16 v[240:243], v[152:155], v[128:131], v[240:243]
    v_mfma_f32_16x16x32_bf16 v[244:247], v[156:159], v[128:131], v[244:247]
    v_mfma_f32_16x16x32_bf16 a[32:35], v[92:95], v[128:131], a[32:35]
    ds_read_b64_tr_b16 v[116:117], v58 offset:7360
    ds_read_b64_tr_b16 v[118:119], v58 offset:9152
    ds_read_b128 v[120:123], v46 offset:704
    ds_read_b128 v[124:127], v46 offset:17600
    s_waitcnt lgkmcnt(14)
    v_mfma_f32_16x16x32_bf16 v[176:179], v[132:135], v[160:163], v[176:179]
    v_mfma_f32_16x16x32_bf16 v[180:183], v[132:135], v[164:167], v[180:183]
    v_mfma_f32_16x16x32_bf16 a[0:3], v[132:135], v[92:95], a[0:3]
    s_waitcnt vmcnt(8)
    s_barrier
    v_add_u32 v58, 111616, v44
    v_add_u32 v59, 95232, v45
    v_add_u32 v60, 95232, v43
    ds_read_b128 v[136:139], v59 offset:0
    s_waitcnt lgkmcnt(13)
    v_mfma_f32_16x16x32_bf16 v[184:187], v[96:99], v[160:163], v[184:187]
    v_mfma_f32_16x16x32_bf16 v[188:191], v[96:99], v[164:167], v[188:191]
    v_mfma_f32_16x16x32_bf16 a[4:7], v[96:99], v[92:95], a[4:7]
    v_mfma_f32_16x16x32_bf16 a[36:39], v[92:95], v[160:163], a[36:39]
    ds_read_b128 v[140:143], v59 offset:2048
    s_waitcnt lgkmcnt(12)
    v_mfma_f32_16x16x32_bf16 v[192:195], v[100:103], v[160:163], v[192:195]
    v_mfma_f32_16x16x32_bf16 v[196:199], v[100:103], v[164:167], v[196:199]
    v_mfma_f32_16x16x32_bf16 a[8:11], v[100:103], v[92:95], a[8:11]
    s_add_u32 m0, s73, 156672
    s_nop 0
    buffer_load_dwordx4 v26, s[40:43], s64 offen lds
    s_cmp_eq_u32 s21, 3
    s_cbranch_scc1 KA_NOW2
    s_add_u32 m0, s73, 160768
    s_add_u32 s66, s64, 65536
    s_nop 0
    buffer_load_dwordx4 v26, s[40:43], s66 offen lds
KA_NOW2:
    ds_read_b64_tr_b16 v[128:129], v58 offset:0
    ds_read_b64_tr_b16 v[130:131], v58 offset:1792
    s_waitcnt lgkmcnt(12)
    v_mfma_f32_16x16x32_bf16 v[200:203], v[104:107], v[160:163], v[200:203]
    v_mfma_f32_16x16x32_bf16 v[204:207], v[104:107], v[164:167], v[204:207]
    v_mfma_f32_16x16x32_bf16 a[12:15], v[104:107], v[92:95], a[12:15]
    v_mfma_f32_16x16x32_bf16 a[44:47], v[160:163], v[160:163], a[44:47]
    ds_read_b64_tr_b16 v[132:133], v58 offset:32
    ds_read_b64_tr_b16 v[134:135], v58 offset:1824
    s_waitcnt lgkmcnt(12)
    v_mfma_f32_16x16x32_bf16 v[208:211], v[108:111], v[160:163], v[208:211]
    v_mfma_f32_16x16x32_bf16 v[212:215], v[108:111], v[164:167], v[212:215]
    v_mfma_f32_16x16x32_bf16 a[16:19], v[108:111], v[92:95], a[16:19]
    ds_read_b64_tr_b16 v[96:97], v58 offset:64
    ds_read_b64_tr_b16 v[98:99], v58 offset:1856
    s_waitcnt lgkmcnt(12)
    v_mfma_f32_16x16x32_bf16 v[216:219], v[112:115], v[160:163], v[216:219]
    v_mfma_f32_16x16x32_bf16 v[220:223], v[112:115], v[164:167], v[220:223]
    v_mfma_f32_16x16x32_bf16 a[20:23], v[112:115], v[92:95], a[20:23]
    v_mfma_f32_16x16x32_bf16 a[40:43], v[92:95], v[164:167], a[40:43]
    ds_read_b64_tr_b16 v[100:101], v58 offset:96
    ds_read_b64_tr_b16 v[102:103], v58 offset:1888
    s_waitcnt lgkmcnt(12)
    v_mfma_f32_16x16x32_bf16 v[224:227], v[116:119], v[160:163], v[224:227]
    v_mfma_f32_16x16x32_bf16 v[228:231], v[116:119], v[164:167], v[228:231]
    v_mfma_f32_16x16x32_bf16 a[24:27], v[116:119], v[92:95], a[24:27]
    ds_read_b64_tr_b16 v[104:105], v58 offset:128
    ds_read_b64_tr_b16 v[106:107], v58 offset:1920
    s_waitcnt lgkmcnt(13)
    v_mfma_f32_16x16x32_bf16 v[232:235], v[160:163], v[120:123], v[232:235]
    v_mfma_f32_16x16x32_bf16 v[236:239], v[164:167], v[120:123], v[236:239]
    v_mfma_f32_16x16x32_bf16 a[28:31], v[92:95], v[120:123], a[28:31]
    v_mfma_f32_16x16x32_bf16 a[48:51], v[164:167], v[164:167], a[48:51]
    ds_read_b64_tr_b16 v[108:109], v58 offset:160
    ds_read_b64_tr_b16 v[110:111], v58 offset:1952
    s_waitcnt lgkmcnt(14)
    v_mfma_f32_16x16x32_bf16 v[240:243], v[160:163], v[124:127], v[240:243]
    v_mfma_f32_16x16x32_bf16 v[244:247], v[164:167], v[124:127], v[244:247]
    v_mfma_f32_16x16x32_bf16 a[32:35], v[92:95], v[124:127], a[32:35]
    ds_read_b64_tr_b16 v[112:113], v58 offset:192
    ds_read_b64_tr_b16 v[114:115], v58 offset:1984
    ds_read_b128 v[116:119], v46 offset:768
    ds_read_b128 v[120:123], v46 offset:17664
    s_waitcnt lgkmcnt(14)
    v_mfma_f32_16x16x32_bf16 v[176:179], v[128:131], v[136:139], v[176:179]
    v_mfma_f32_16x16x32_bf16 v[180:183], v[128:131], v[140:143], v[180:183]
    v_mfma_f32_16x16x32_bf16 a[0:3], v[128:131], v[92:95], a[0:3]
    ds_read_b128 v[144:147], v60 offset:0
    s_waitcnt lgkmcnt(13)
    v_mfma_f32_16x16x32_bf16 v[184:187], v[132:135], v[136:139], v[184:187]
    v_mfma_f32_16x16x32_bf16 v[188:191], v[132:135], v[140:143], v[188:191]
    v_mfma_f32_16x16x32_bf16 a[4:7], v[132:135], v[92:95], a[4:7]
    v_mfma_f32_16x16x32_bf16 a[36:39], v[92:95], v[136:139], a[36:39]
    ds_read_b128 v[148:151], v60 offset:2048
    s_waitcnt lgkmcnt(12)
    v_mfma_f32_16x16x32_bf16 v[192:195], v[96:99], v[136:139], v[192:195]
    v_mfma_f32_16x16x32_bf16 v[196:199], v[96:99], v[140:143], v[196:199]
    v_mfma_f32_16x16x32_bf16 a[8:11], v[96:99], v[92:95], a[8:11]
    ds_read_b64_tr_b16 v[124:125], v58 offset:7168
    ds_read_b64_tr_b16 v[126:127], v58 offset:8960
    s_waitcnt lgkmcnt(12)
    v_mfma_f32_16x16x32_bf16 v[200:203], v[100:103], v[136:139], v[200:203]
    v_mfma_f32_16x16x32_bf16 v[204:207], v[100:103], v[140:143], v[204:207]
    v_mfma_f32_16x16x32_bf16 a[12:15], v[100:103], v[92:95], a[12:15]
    v_mfma_f32_16x16x32_bf16 a[44:47], v[136:139], v[136:139], a[44:47]
    ds_read_b64_tr_b16 v[128:129], v58 offset:7200
    ds_read_b64_tr_b16 v[130:131], v58 offset:8992
    s_waitcnt lgkmcnt(12)
    v_mfma_f32_16x16x32_bf16 v[208:211], v[104:107], v[136:139], v[208:211]
    v_mfma_f32_16x16x32_bf16 v[212:215], v[104:107], v[140:143], v[212:215]
    v_mfma_f32_16x16x32_bf16 a[16:19], v[104:107], v[92:95], a[16:19]
    ds_read_b64_tr_b16 v[132:133], v58 offset:7232
    ds_read_b64_tr_b16 v[134:135], v58 offset:9024
    s_waitcnt lgkmcnt(12)
    v_mfma_f32_16x16x32_bf16 v[216:219], v[108:111], v[136:139], v[216:219]
    v_mfma_f32_16x16x32_bf16 v[220:223], v[108:111], v[140:143], v[220:223]
    v_mfma_f32_16x16x32_bf16 a[20:23], v[108:111], v[92:95], a[20:23]
    v_mfma_f32_16x16x32_bf16 a[40:43], v[92:95], v[140:143], a[40:43]
    ds_read_b64_tr_b16 v[96:97], v58 offset:7264
    ds_read_b64_tr_b16 v[98:99], v58 offset:9056
    s_waitcnt lgkmcnt(12)
    v_mfma_f32_16x16x32_bf16 v[224:227], v[112:115], v[136:139], v[224:227]
    v_mfma_f32_16x16x32_bf16 v[228:231], v[112:115], v[140:143], v[228:231]
    v_mfma_f32_16x16x32_bf16 a[24:27], v[112:115], v[92:95], a[24:27]
    ds_read_b64_tr_b16 v[100:101], v58 offset:7296
    ds_read_b64_tr_b16 v[102:103], v58 offset:9088
    s_waitcnt lgkmcnt(13)
    v_mfma_f32_16x16x32_bf16 v[232:235], v[136:139], v[116:119], v[232:235]
    v_mfma_f32_16x16x32_bf16 v[236:239], v[140:143], v[116:119], v[236:239]
    v_mfma_f32_16x16x32_bf16 a[28:31], v[92:95], v[116:119], a[28:31]
    v_mfma_f32_16x16x32_bf16 a[48:51], v[140:143], v[140:143], a[48:51]
    ds_read_b64_tr_b16 v[104:105], v58 offset:7328
    ds_read_b64_tr_b16 v[106:107], v58 offset:9120
    s_waitcnt lgkmcnt(14)
    v_mfma_f32_16x16x32_bf16 v[240:243], v[136:139], v[120:123], v[240:243]
    v_mfma_f32_16x16x32_bf16 v[244:247], v[140:143], v[120:123], v[244:247]
    v_mfma_f32_16x16x32_bf16 a[32:35], v[92:95], v[120:123], a[32:35]
    ds_read_b64_tr_b16 v[108:109], v58 offset:7360
    ds_read_b64_tr_b16 v[110:111], v58 offset:9152
    ds_read_b128 v[112:115], v46 offset:832
    ds_read_b128 v[116:119], v46 offset:17728
    s_waitcnt lgkmcnt(14)
    v_mfma_f32_16x16x32_bf16 v[176:179], v[124:127], v[144:147], v[176:179]
    v_mfma_f32_16x16x32_bf16 v[180:183], v[124:127], v[148:151], v[180:183]
    v_mfma_f32_16x16x32_bf16 a[0:3], v[124:127], v[92:95], a[0:3]
    s_waitcnt vmcnt(1)
    s_barrier
    v_add_u32 v58, 142336, v44
    v_add_u32 v59, 125952, v45
    v_add_u32 v60, 125952, v43
    ds_read_b128 v[152:155], v59 offset:0
    s_waitcnt lgkmcnt(13)
    v_mfma_f32_16x16x32_bf16 v[184:187], v[128:131], v[144:147], v[184:187]
    v_mfma_f32_16x16x32_bf16 v[188:191], v[128:131], v[148:151], v[188:191]
    v_mfma_f32_16x16x32_bf16 a[4:7], v[128:131], v[92:95], a[4:7]
    v_mfma_f32_16x16x32_bf16 a[36:39], v[92:95], v[144:147], a[36:39]
    ds_read_b128 v[156:159], v59 offset:2048
    s_waitcnt lgkmcnt(12)
    v_mfma_f32_16x16x32_bf16 v[192:195], v[132:135], v[144:147], v[192:195]
    v_mfma_f32_16x16x32_bf16 v[196:199], v[132:135], v[148:151], v[196:199]
    v_mfma_f32_16x16x32_bf16 a[8:11], v[132:135], v[92:95], a[8:11]
    s_mov_b32 s4, s76
    s_mov_b32 s5, s77
    s_and_b32 s5, s5, 0xffff
    s_mov_b32 s6, 8388608
    s_mov_b32 s7, 0x00020000
    s_mov_b32 s8, s78
    s_mov_b32 s9, s79
    s_and_b32 s9, s9, 0xffff
    s_mov_b32 s10, 8388608
    s_mov_b32 s11, 0x00020000
    buffer_load_dwordx4 v[72:75], v10, s[4:7], s23 offen offset:0
    buffer_load_dwordx4 v[72:75], v10, s[4:7], s23 offen offset:1024
    buffer_load_dwordx4 v[72:75], v10, s[8:11], s23 offen offset:0
    buffer_load_dwordx4 v[72:75], v10, s[8:11], s23 offen offset:1024
    ds_read_b64_tr_b16 v[120:121], v58 offset:0
    ds_read_b64_tr_b16 v[122:123], v58 offset:1792
    s_waitcnt lgkmcnt(12)
    v_mfma_f32_16x16x32_bf16 v[200:203], v[96:99], v[144:147], v[200:203]
    v_mfma_f32_16x16x32_bf16 v[204:207], v[96:99], v[148:151], v[204:207]
    v_mfma_f32_16x16x32_bf16 a[12:15], v[96:99], v[92:95], a[12:15]
    v_mfma_f32_16x16x32_bf16 a[44:47], v[144:147], v[144:147], a[44:47]
    ds_read_b64_tr_b16 v[124:125], v58 offset:32
    ds_read_b64_tr_b16 v[126:127], v58 offset:1824
    s_waitcnt lgkmcnt(12)
    v_mfma_f32_16x16x32_bf16 v[208:211], v[100:103], v[144:147], v[208:211]
    v_mfma_f32_16x16x32_bf16 v[212:215], v[100:103], v[148:151], v[212:215]
    v_mfma_f32_16x16x32_bf16 a[16:19], v[100:103], v[92:95], a[16:19]
    ds_read_b64_tr_b16 v[128:129], v58 offset:64
    ds_read_b64_tr_b16 v[130:131], v58 offset:1856
    s_waitcnt lgkmcnt(12)
    v_mfma_f32_16x16x32_bf16 v[216:219], v[104:107], v[144:147], v[216:219]
    v_mfma_f32_16x16x32_bf16 v[220:223], v[104:107], v[148:151], v[220:223]
    v_mfma_f32_16x16x32_bf16 a[20:23], v[104:107], v[92:95], a[20:23]
    v_mfma_f32_16x16x32_bf16 a[40:43], v[92:95], v[148:151], a[40:43]
    ds_read_b64_tr_b16 v[132:133], v58 offset:96
    ds_read_b64_tr_b16 v[134:135], v58 offset:1888
    s_waitcnt lgkmcnt(12)
    v_mfma_f32_16x16x32_bf16 v[224:227], v[108:111], v[144:147], v[224:227]
    v_mfma_f32_16x16x32_bf16 v[228:231], v[108:111], v[148:151], v[228:231]
    v_mfma_f32_16x16x32_bf16 a[24:27], v[108:111], v[92:95], a[24:27]
    ds_read_b64_tr_b16 v[96:97], v58 offset:128
    ds_read_b64_tr_b16 v[98:99], v58 offset:1920
    s_waitcnt lgkmcnt(13)
    v_mfma_f32_16x16x32_bf16 v[232:235], v[144:147], v[112:115], v[232:235]
    v_mfma_f32_16x16x32_bf16 v[236:239], v[148:151], v[112:115], v[236:239]
    v_mfma_f32_16x16x32_bf16 a[28:31], v[92:95], v[112:115], a[28:31]
    v_mfma_f32_16x16x32_bf16 a[48:51], v[148:151], v[148:151], a[48:51]
    ds_read_b64_tr_b16 v[100:101], v58 offset:160
    ds_read_b64_tr_b16 v[102:103], v58 offset:1952
    s_waitcnt lgkmcnt(14)
    v_mfma_f32_16x16x32_bf16 v[240:243], v[144:147], v[116:119], v[240:243]
    v_mfma_f32_16x16x32_bf16 v[244:247], v[148:151], v[116:119], v[244:247]
    v_mfma_f32_16x16x32_bf16 a[32:35], v[92:95], v[116:119], a[32:35]
    ds_read_b64_tr_b16 v[104:105], v58 offset:192
    ds_read_b64_tr_b16 v[106:107], v58 offset:1984
    ds_read_b128 v[108:111], v46 offset:896
    ds_read_b128 v[112:115], v46 offset:17792
    s_waitcnt lgkmcnt(14)
    v_mfma_f32_16x16x32_bf16 v[176:179], v[120:123], v[152:155], v[176:179]
    v_mfma_f32_16x16x32_bf16 v[180:183], v[120:123], v[156:159], v[180:183]
    v_mfma_f32_16x16x32_bf16 a[0:3], v[120:123], v[92:95], a[0:3]
    ds_read_b128 v[160:163], v60 offset:0
    s_waitcnt lgkmcnt(13)
    v_mfma_f32_16x16x32_bf16 v[184:187], v[124:127], v[152:155], v[184:187]
    v_mfma_f32_16x16x32_bf16 v[188:191], v[124:127], v[156:159], v[188:191]
    v_mfma_f32_16x16x32_bf16 a[4:7], v[124:127], v[92:95], a[4:7]
    v_mfma_f32_16x16x32_bf16 a[36:39], v[92:95], v[152:155], a[36:39]
    ds_read_b128 v[164:167], v60 offset:2048
    s_waitcnt lgkmcnt(12)
    v_mfma_f32_16x16x32_bf16 v[192:195], v[128:131], v[152:155], v[192:195]
    v_mfma_f32_16x16x32_bf16 v[196:199], v[128:131], v[156:159], v[196:199]
    v_mfma_f32_16x16x32_bf16 a[8:11], v[128:131], v[92:95], a[8:11]
    ds_read_b64_tr_b16 v[116:117], v58 offset:7168
    ds_read_b64_tr_b16 v[118:119], v58 offset:8960
    s_waitcnt lgkmcnt(12)
    v_mfma_f32_16x16x32_bf16 v[200:203], v[132:135], v[152:155], v[200:203]
    v_mfma_f32_16x16x32_bf16 v[204:207], v[132:135], v[156:159], v[204:207]
    v_mfma_f32_16x16x32_bf16 a[12:15], v[132:135], v[92:95], a[12:15]
    v_mfma_f32_16x16x32_bf16 a[44:47], v[152:155], v[152:155], a[44:47]
    ds_read_b64_tr_b16 v[120:121], v58 offset:7200
    ds_read_b64_tr_b16 v[122:123], v58 offset:8992
    s_waitcnt lgkmcnt(12)
    v_mfma_f32_16x16x32_bf16 v[208:211], v[96:99], v[152:155], v[208:211]
    v_mfma_f32_16x16x32_bf16 v[212:215], v[96:99], v[156:159], v[212:215]
    v_mfma_f32_16x16x32_bf16 a[16:19], v[96:99], v[92:95], a[16:19]
    ds_read_b64_tr_b16 v[124:125], v58 offset:7232
    ds_read_b64_tr_b16 v[126:127], v58 offset:9024
    s_waitcnt lgkmcnt(12)
    v_mfma_f32_16x16x32_bf16 v[216:219], v[100:103], v[152:155], v[216:219]
    v_mfma_f32_16x16x32_bf16 v[220:223], v[100:103], v[156:159], v[220:223]
    v_mfma_f32_16x16x32_bf16 a[20:23], v[100:103], v[92:95], a[20:23]
    v_mfma_f32_16x16x32_bf16 a[40:43], v[92:95], v[156:159], a[40:43]
    ds_read_b64_tr_b16 v[128:129], v58 offset:7264
    ds_read_b64_tr_b16 v[130:131], v58 offset:9056
    s_waitcnt lgkmcnt(12)
    v_mfma_f32_16x16x32_bf16 v[224:227], v[104:107], v[152:155], v[224:227]
    v_mfma_f32_16x16x32_bf16 v[228:231], v[104:107], v[156:159], v[228:231]
    v_mfma_f32_16x16x32_bf16 a[24:27], v[104:107], v[92:95], a[24:27]
    ds_read_b64_tr_b16 v[132:133], v58 offset:7296
    ds_read_b64_tr_b16 v[134:135], v58 offset:9088
    s_waitcnt lgkmcnt(13)
    v_mfma_f32_16x16x32_bf16 v[232:235], v[152:155], v[108:111], v[232:235]
    v_mfma_f32_16x16x32_bf16 v[236:239], v[156:159], v[108:111], v[236:239]
    v_mfma_f32_16x16x32_bf16 a[28:31], v[92:95], v[108:111], a[28:31]
    v_mfma_f32_16x16x32_bf16 a[48:51], v[156:159], v[156:159], a[48:51]
    ds_read_b64_tr_b16 v[96:97], v58 offset:7328
    ds_read_b64_tr_b16 v[98:99], v58 offset:9120
    s_waitcnt lgkmcnt(14)
    v_mfma_f32_16x16x32_bf16 v[240:243], v[152:155], v[112:115], v[240:243]
    v_mfma_f32_16x16x32_bf16 v[244:247], v[156:159], v[112:115], v[244:247]
    v_mfma_f32_16x16x32_bf16 a[32:35], v[92:95], v[112:115], a[32:35]
    ds_read_b64_tr_b16 v[100:101], v58 offset:7360
    ds_read_b64_tr_b16 v[102:103], v58 offset:9152
    ds_read_b128 v[104:107], v46 offset:960
    ds_read_b128 v[108:111], v46 offset:17856
    s_waitcnt lgkmcnt(14)
    v_mfma_f32_16x16x32_bf16 v[176:179], v[116:119], v[160:163], v[176:179]
    v_mfma_f32_16x16x32_bf16 v[180:183], v[116:119], v[164:167], v[180:183]
    v_mfma_f32_16x16x32_bf16 a[0:3], v[116:119], v[92:95], a[0:3]
    s_waitcnt lgkmcnt(12)
    v_mfma_f32_16x16x32_bf16 v[184:187], v[120:123], v[160:163], v[184:187]
    v_mfma_f32_16x16x32_bf16 v[188:191], v[120:123], v[164:167], v[188:191]
    v_mfma_f32_16x16x32_bf16 a[4:7], v[120:123], v[92:95], a[4:7]
    v_mfma_f32_16x16x32_bf16 a[36:39], v[92:95], v[160:163], a[36:39]
    s_waitcnt lgkmcnt(10)
    v_mfma_f32_16x16x32_bf16 v[192:195], v[124:127], v[160:163], v[192:195]
    v_mfma_f32_16x16x32_bf16 v[196:199], v[124:127], v[164:167], v[196:199]
    v_mfma_f32_16x16x32_bf16 a[8:11], v[124:127], v[92:95], a[8:11]
    s_waitcnt lgkmcnt(8)
    v_mfma_f32_16x16x32_bf16 v[200:203], v[128:131], v[160:163], v[200:203]
    v_mfma_f32_16x16x32_bf16 v[204:207], v[128:131], v[164:167], v[204:207]
    v_mfma_f32_16x16x32_bf16 a[12:15], v[128:131], v[92:95], a[12:15]
    v_mfma_f32_16x16x32_bf16 a[44:47], v[160:163], v[160:163], a[44:47]
    s_waitcnt lgkmcnt(6)
    v_mfma_f32_16x16x32_bf16 v[208:211], v[132:135], v[160:163], v[208:211]
    v_mfma_f32_16x16x32_bf16 v[212:215], v[132:135], v[164:167], v[212:215]
    v_mfma_f32_16x16x32_bf16 a[16:19], v[132:135], v[92:95], a[16:19]
    s_waitcnt lgkmcnt(4)
    v_mfma_f32_16x16x32_bf16 v[216:219], v[96:99], v[160:163], v[216:219]
    v_mfma_f32_16x16x32_bf16 v[220:223], v[96:99], v[164:167], v[220:223]
    v_mfma_f32_16x16x32_bf16 a[20:23], v[96:99], v[92:95], a[20:23]
    v_mfma_f32_16x16x32_bf16 a[40:43], v[92:95], v[164:167], a[40:43]
    s_waitcnt lgkmcnt(2)
    v_mfma_f32_16x16x32_bf16 v[224:227], v[100:103], v[160:163], v[224:227]
    v_mfma_f32_16x16x32_bf16 v[228:231], v[100:103], v[164:167], v[228:231]
    v_mfma_f32_16x16x32_bf16 a[24:27], v[100:103], v[92:95], a[24:27]
    s_waitcnt lgkmcnt(1)
    v_mfma_f32_16x16x32_bf16 v[232:235], v[160:163], v[104:107], v[232:235]
    v_mfma_f32_16x16x32_bf16 v[236:239], v[164:167], v[104:107], v[236:239]
    v_mfma_f32_16x16x32_bf16 a[28:31], v[92:95], v[104:107], a[28:31]
    v_mfma_f32_16x16x32_bf16 a[48:51], v[164:167], v[164:167], a[48:51]
    s_waitcnt lgkmcnt(0)
    v_mfma_f32_16x16x32_bf16 v[240:243], v[160:163], v[108:111], v[240:243]
    v_mfma_f32_16x16x32_bf16 v[244:247], v[164:167], v[108:111], v[244:247]
    v_mfma_f32_16x16x32_bf16 a[32:35], v[92:95], v[108:111], a[32:35]
    s_waitcnt vmcnt(4)
    ds_read_b64_tr_b16 v[50:51], v47 offset:0
    ds_read_b64_tr_b16 v[52:53], v47 offset:256
    ds_read_b64_tr_b16 v[54:55], v47 offset:4096
    ds_read_b64_tr_b16 v[56:57], v47 offset:4352
    v_and_b32 v96, 3, v2
    v_lshrrev_b32 v97, 2, v2
    v_lshl_add_u32 v97, v97, 4, v2
    v_lshlrev_b32 v97, 2, v97
    v_accvgpr_read_b32 v42, a36
    v_accvgpr_read_b32 v100, a44
    v_accvgpr_read_b32 v101, a45
    v_accvgpr_read_b32 v102, a46
    v_accvgpr_read_b32 v103, a47
    v_accvgpr_read_b32 v43, a40
    v_accvgpr_read_b32 v104, a48
    v_accvgpr_read_b32 v105, a49
    v_accvgpr_read_b32 v106, a50
    v_accvgpr_read_b32 v107, a51
    v_cmp_eq_u32 vcc, 1, v96
    s_nop 1
    v_cndmask_b32 v100, v100, v101, vcc
    v_cndmask_b32 v104, v104, v105, vcc
    v_cmp_eq_u32 vcc, 2, v96
    s_nop 1
    v_cndmask_b32 v100, v100, v102, vcc
    v_cndmask_b32 v104, v104, v106, vcc
    v_cmp_eq_u32 vcc, 3, v96
    s_nop 1
    v_cndmask_b32 v100, v100, v103, vcc
    v_cndmask_b32 v104, v104, v107, vcc
    ds_bpermute_b32 v44, v97, v100
    ds_bpermute_b32 v45, v97, v104
    v_accvgpr_read_b32 v116, a0
    v_accvgpr_read_b32 v117, a1
    v_accvgpr_read_b32 v118, a2
    v_accvgpr_read_b32 v119, a3
    v_accvgpr_read_b32 v120, a4
    v_accvgpr_read_b32 v121, a5
    v_accvgpr_read_b32 v122, a6
    v_accvgpr_read_b32 v123, a7
    v_accvgpr_read_b32 v124, a8
    v_accvgpr_read_b32 v125, a9
    v_accvgpr_read_b32 v126, a10
    v_accvgpr_read_b32 v127, a11
    v_accvgpr_read_b32 v128, a12
    v_accvgpr_read_b32 v129, a13
    v_accvgpr_read_b32 v130, a14
    v_accvgpr_read_b32 v131, a15
    v_accvgpr_read_b32 v132, a16
    v_accvgpr_read_b32 v133, a17
    v_accvgpr_read_b32 v134, a18
    v_accvgpr_read_b32 v135, a19
    v_accvgpr_read_b32 v136, a20
    v_accvgpr_read_b32 v137, a21
    v_accvgpr_read_b32 v138, a22
    v_accvgpr_read_b32 v139, a23
    v_accvgpr_read_b32 v140, a24
    v_accvgpr_read_b32 v141, a25
    v_accvgpr_read_b32 v142, a26
    v_accvgpr_read_b32 v143, a27
    v_accvgpr_read_b32 v144, a28
    v_accvgpr_read_b32 v145, a29
    v_accvgpr_read_b32 v146, a30
    v_accvgpr_read_b32 v147, a31
    v_accvgpr_read_b32 v148, a32
    v_accvgpr_read_b32 v149, a33
    v_accvgpr_read_b32 v150, a34
    v_accvgpr_read_b32 v151, a35
    s_waitcnt lgkmcnt(0)
    v_lshrrev_b32 v48, 1, v3
    v_lshl_add_u32 v48, v48, 4, v2
    s_lshl_b32 s65, s19, 5
    v_add_u32 v48, s65, v48
    v_mul_lo_u32 v48, v48, s61
    v_and_b32 v49, 1, v3
    v_lshl_add_u32 v48, v49, 4, v48
    s_mul_i32 s65, s20, 224
    s_lshl_b32 s66, s21, 5
    s_add_u32 s65, s65, s66
    v_add_u32 v48, s65, v48
    buffer_store_dwordx4 v[50:53], v48, s[52:55], 0 offen
    s_cmp_eq_u32 s21, 3
    s_cbranch_scc1 KA_NOT2
    buffer_store_dwordx4 v[54:57], v48, s[52:55], 0 offen offset:128
KA_NOT2:
    s_mov_b32 s67, 0x3b000000
    s_mov_b32 s68, 0x3727c5ac
    v_mul_f32 v96, s67, v42
    v_mul_f32 v98, s67, v44
    v_fma_f32 v98, -v96, v96, v98
    v_max_f32 v98, 0, v98
    v_cvt_pk_bf16_f32 v112, v96, v96
    v_lshlrev_b32 v112, 16, v112
    v_cvt_pk_bf16_f32 v98, v98, v98
    v_lshlrev_b32 v98, 16, v98
    v_add_f32 v98, s68, v98
    v_cvt_pk_bf16_f32 v98, v98, v98
    v_lshlrev_b32 v98, 16, v98
    v_sqrt_f32 v98, v98
    s_nop 0
    v_cvt_pk_bf16_f32 v98, v98, v98
    v_lshlrev_b32 v98, 16, v98
    v_rcp_f32 v108, v98
    s_nop 0
    v_mov_b32 v109, v108
    v_sub_f32 v104, 0, v112
    v_sub_f32 v105, 0, v112
    v_mul_f32 v97, s67, v43
    v_mul_f32 v99, s67, v45
    v_fma_f32 v99, -v97, v97, v99
    v_max_f32 v99, 0, v99
    v_cvt_pk_bf16_f32 v113, v97, v97
    v_lshlrev_b32 v113, 16, v113
    v_cvt_pk_bf16_f32 v99, v99, v99
    v_lshlrev_b32 v99, 16, v99
    v_add_f32 v99, s68, v99
    v_cvt_pk_bf16_f32 v99, v99, v99
    v_lshlrev_b32 v99, 16, v99
    v_sqrt_f32 v99, v99
    s_nop 0
    v_cvt_pk_bf16_f32 v99, v99, v99
    v_lshlrev_b32 v99, 16, v99
    v_rcp_f32 v110, v99
    s_nop 0
    v_mov_b32 v111, v110
    v_sub_f32 v106, 0, v113
    v_sub_f32 v107, 0, v113
    ds_bpermute_b32 v152, v81, v112
    ds_bpermute_b32 v160, v81, v108
    ds_bpermute_b32 v153, v82, v112
    ds_bpermute_b32 v161, v82, v108
    ds_bpermute_b32 v154, v83, v112
    ds_bpermute_b32 v162, v83, v108
    ds_bpermute_b32 v155, v84, v112
    ds_bpermute_b32 v163, v84, v108
    ds_bpermute_b32 v156, v81, v113
    ds_bpermute_b32 v164, v81, v110
    ds_bpermute_b32 v157, v82, v113
    ds_bpermute_b32 v165, v82, v110
    ds_bpermute_b32 v158, v83, v113
    ds_bpermute_b32 v166, v83, v110
    ds_bpermute_b32 v159, v84, v113
    ds_bpermute_b32 v167, v84, v110
    v_pk_fma_f32 v[176:177], v[116:117], v[104:105], v[176:177]
    v_pk_fma_f32 v[178:179], v[118:119], v[104:105], v[178:179]
    v_pk_mul_f32 v[176:177], v[176:177], v[108:109]
    v_pk_mul_f32 v[178:179], v[178:179], v[108:109]
    v_cvt_pk_bf16_f32 v176, v176, v177
    v_cvt_pk_bf16_f32 v177, v178, v179
    v_pk_max_i16 v176, v176, 0
    v_pk_max_i16 v177, v177, 0
    buffer_store_dwordx2 v[176:177], v61, s[44:47], 0 offen offset:0
    v_pk_fma_f32 v[180:181], v[116:117], v[106:107], v[180:181]
    v_pk_fma_f32 v[182:183], v[118:119], v[106:107], v[182:183]
    v_pk_mul_f32 v[180:181], v[180:181], v[110:111]
    v_pk_mul_f32 v[182:183], v[182:183], v[110:111]
    v_cvt_pk_bf16_f32 v180, v180, v181
    v_cvt_pk_bf16_f32 v181, v182, v183
    v_pk_max_i16 v180, v180, 0
    v_pk_max_i16 v181, v181, 0
    buffer_store_dwordx2 v[180:181], v64, s[44:47], 0 offen offset:0
    v_pk_fma_f32 v[184:185], v[120:121], v[104:105], v[184:185]
    v_pk_fma_f32 v[186:187], v[122:123], v[104:105], v[186:187]
    v_pk_mul_f32 v[184:185], v[184:185], v[108:109]
    v_pk_mul_f32 v[186:187], v[186:187], v[108:109]
    v_cvt_pk_bf16_f32 v184, v184, v185
    v_cvt_pk_bf16_f32 v185, v186, v187
    v_pk_max_i16 v184, v184, 0
    v_pk_max_i16 v185, v185, 0
    buffer_store_dwordx2 v[184:185], v61, s[44:47], 0 offen offset:32
    v_pk_fma_f32 v[188:189], v[120:121], v[106:107], v[188:189]
    v_pk_fma_f32 v[190:191], v[122:123], v[106:107], v[190:191]
    v_pk_mul_f32 v[188:189], v[188:189], v[110:111]
    v_pk_mul_f32 v[190:191], v[190:191], v[110:111]
    v_cvt_pk_bf16_f32 v188, v188, v189
    v_cvt_pk_bf16_f32 v189, v190, v191
    v_pk_max_i16 v188, v188, 0
    v_pk_max_i16 v189, v189, 0
    buffer_store_dwordx2 v[188:189], v64, s[44:47], 0 offen offset:32
    v_pk_fma_f32 v[192:193], v[124:125], v[104:105], v[192:193]
    v_pk_fma_f32 v[194:195], v[126:127], v[104:105], v[194:195]
    v_pk_mul_f32 v[192:193], v[192:193], v[108:109]
    v_pk_mul_f32 v[194:195], v[194:195], v[108:109]
    v_cvt_pk_bf16_f32 v192, v192, v193
    v_cvt_pk_bf16_f32 v193, v194, v195
    v_pk_max_i16 v192, v192, 0
    v_pk_max_i16 v193, v193, 0
    buffer_store_dwordx2 v[192:193], v61, s[44:47], 0 offen offset:64
    v_pk_fma_f32 v[196:197], v[124:125], v[106:107], v[196:197]
    v_pk_fma_f32 v[198:199], v[126:127], v[106:107], v[198:199]
    v_pk_mul_f32 v[196:197], v[196:197], v[110:111]
    v_pk_mul_f32 v[198:199], v[198:199], v[110:111]
    v_cvt_pk_bf16_f32 v196, v196, v197
    v_cvt_pk_bf16_f32 v197, v198, v199
    v_pk_max_i16 v196, v196, 0
    v_pk_max_i16 v197, v197, 0
    buffer_store_dwordx2 v[196:197], v64, s[44:47], 0 offen offset:64
    v_pk_fma_f32 v[200:201], v[128:129], v[104:105], v[200:201]
    v_pk_fma_f32 v[202:203], v[130:131], v[104:105], v[202:203]
    v_pk_mul_f32 v[200:201], v[200:201], v[108:109]
    v_pk_mul_f32 v[202:203], v[202:203], v[108:109]
    v_cvt_pk_bf16_f32 v200, v200, v201
    v_cvt_pk_bf16_f32 v201, v202, v203
    v_pk_max_i16 v200, v200, 0
    v_pk_max_i16 v201, v201, 0
    buffer_store_dwordx2 v[200:201], v61, s[44:47], 0 offen offset:96
    v_pk_fma_f32 v[204:205], v[128:129], v[106:107], v[204:205]
    v_pk_fma_f32 v[206:207], v[130:131], v[106:107], v[206:207]
    v_pk_mul_f32 v[204:205], v[204:205], v[110:111]
    v_pk_mul_f32 v[206:207], v[206:207], v[110:111]
    v_cvt_pk_bf16_f32 v204, v204, v205
    v_cvt_pk_bf16_f32 v205, v206, v207
    v_pk_max_i16 v204, v204, 0
    v_pk_max_i16 v205, v205, 0
    buffer_store_dwordx2 v[204:205], v64, s[44:47], 0 offen offset:96
    v_pk_fma_f32 v[208:209], v[132:133], v[104:105], v[208:209]
    v_pk_fma_f32 v[210:211], v[134:135], v[104:105], v[210:211]
    v_pk_mul_f32 v[208:209], v[208:209], v[108:109]
    v_pk_mul_f32 v[210:211], v[210:211], v[108:109]
    v_cvt_pk_bf16_f32 v208, v208, v209
    v_cvt_pk_bf16_f32 v209, v210, v211
    v_pk_max_i16 v208, v208, 0
    v_pk_max_i16 v209, v209, 0
    buffer_store_dwordx2 v[208:209], v61, s[44:47], 0 offen offset:128
    v_pk_fma_f32 v[212:213], v[132:133], v[106:107], v[212:213]
    v_pk_fma_f32 v[214:215], v[134:135], v[106:107], v[214:215]
    v_pk_mul_f32 v[212:213], v[212:213], v[110:111]
    v_pk_mul_f32 v[214:215], v[214:215], v[110:111]
    v_cvt_pk_bf16_f32 v212, v212, v213
    v_cvt_pk_bf16_f32 v213, v214, v215
    v_pk_max_i16 v212, v212, 0
    v_pk_max_i16 v213, v213, 0
    buffer_store_dwordx2 v[212:213], v64, s[44:47], 0 offen offset:128
    v_pk_fma_f32 v[216:217], v[136:137], v[104:105], v[216:217]
    v_pk_fma_f32 v[218:219], v[138:139], v[104:105], v[218:219]
    v_pk_mul_f32 v[216:217], v[216:217], v[108:109]
    v_pk_mul_f32 v[218:219], v[218:219], v[108:109]
    v_cvt_pk_bf16_f32 v216, v216, v217
    v_cvt_pk_bf16_f32 v217, v218, v219
    v_pk_max_i16 v216, v216, 0
    v_pk_max_i16 v217, v217, 0
    buffer_store_dwordx2 v[216:217], v61, s[44:47], 0 offen offset:160
    v_pk_fma_f32 v[220:221], v[136:137], v[106:107], v[220:221]
    v_pk_fma_f32 v[222:223], v[138:139], v[106:107], v[222:223]
    v_pk_mul_f32 v[220:221], v[220:221], v[110:111]
    v_pk_mul_f32 v[222:223], v[222:223], v[110:111]
    v_cvt_pk_bf16_f32 v220, v220, v221
    v_cvt_pk_bf16_f32 v221, v222, v223
    v_pk_max_i16 v220, v220, 0
    v_pk_max_i16 v221, v221, 0
    buffer_store_dwordx2 v[220:221], v64, s[44:47], 0 offen offset:160
    v_pk_fma_f32 v[224:225], v[140:141], v[104:105], v[224:225]
    v_pk_fma_f32 v[226:227], v[142:143], v[104:105], v[226:227]
    v_pk_mul_f32 v[224:225], v[224:225], v[108:109]
    v_pk_mul_f32 v[226:227], v[226:227], v[108:109]
    v_cvt_pk_bf16_f32 v224, v224, v225
    v_cvt_pk_bf16_f32 v225, v226, v227
    v_pk_max_i16 v224, v224, 0
    v_pk_max_i16 v225, v225, 0
    buffer_store_dwordx2 v[224:225], v61, s[44:47], 0 offen offset:192
    v_pk_fma_f32 v[228:229], v[140:141], v[106:107], v[228:229]
    v_pk_fma_f32 v[230:231], v[142:143], v[106:107], v[230:231]
    v_pk_mul_f32 v[228:229], v[228:229], v[110:111]
    v_pk_mul_f32 v[230:231], v[230:231], v[110:111]
    v_cvt_pk_bf16_f32 v228, v228, v229
    v_cvt_pk_bf16_f32 v229, v230, v231
    v_pk_max_i16 v228, v228, 0
    v_pk_max_i16 v229, v229, 0
    buffer_store_dwordx2 v[228:229], v64, s[44:47], 0 offen offset:192
    s_mov_b32 s72, 34816
    s_waitcnt lgkmcnt(0)
    v_add_u32 v168, 0, v65
    v_cmp_gt_u32 vcc, 0x101, v168
    s_nop 1
    v_cndmask_b32 v168, v68, v63, vcc
    v_mul_f32 v169, v168, v86
    v_fma_f32 v232, -v152, v144, v232
    v_fma_f32 v236, -v156, v144, v236
    v_fma_f32 v233, -v153, v144, v233
    v_fma_f32 v237, -v157, v144, v237
    v_fma_f32 v234, -v154, v144, v234
    v_fma_f32 v238, -v158, v144, v238
    v_fma_f32 v235, -v155, v144, v235
    v_fma_f32 v239, -v159, v144, v239
    v_mul_f32 v232, v160, v232
    v_mul_f32 v236, v164, v236
    v_mul_f32 v233, v161, v233
    v_mul_f32 v237, v165, v237
    v_mul_f32 v234, v162, v234
    v_mul_f32 v238, v166, v238
    v_mul_f32 v235, v163, v235
    v_mul_f32 v239, v167, v239
    v_fma_f32 v232, v169, v236, v232
    v_fma_f32 v233, v168, v237, v233
    v_fma_f32 v234, v168, v238, v234
    v_fma_f32 v235, v168, v239, v235
    v_cvt_pk_bf16_f32 v170, v232, v233
    v_cvt_pk_bf16_f32 v171, v234, v235
    buffer_store_dwordx2 v[170:171], v66, s[48:51], 0 offen
    s_cmp_lg_u32 s22, 0
    s_cbranch_scc1 KA_S0_7
    v_cvt_pk_bf16_f32 v172, v236, v62
    s_mov_b64 s[70:71], exec
    s_mov_b64 exec, 0xffff
    buffer_store_dword v172, v67, s[48:51], 0 offen
    s_mov_b64 exec, s[70:71]
KA_S0_7:
    v_add_u32 v168, 16, v65
    v_cmp_gt_u32 vcc, 0x101, v168
    s_nop 1
    v_cndmask_b32 v168, v68, v63, vcc
    v_mul_f32 v169, v168, v86
    v_fma_f32 v240, -v152, v148, v240
    v_fma_f32 v244, -v156, v148, v244
    v_fma_f32 v241, -v153, v148, v241
    v_fma_f32 v245, -v157, v148, v245
    v_fma_f32 v242, -v154, v148, v242
    v_fma_f32 v246, -v158, v148, v246
    v_fma_f32 v243, -v155, v148, v243
    v_fma_f32 v247, -v159, v148, v247
    v_mul_f32 v240, v160, v240
    v_mul_f32 v244, v164, v244
    v_mul_f32 v241, v161, v241
    v_mul_f32 v245, v165, v245
    v_mul_f32 v242, v162, v242
    v_mul_f32 v246, v166, v246
    v_mul_f32 v243, v163, v243
    v_mul_f32 v247, v167, v247
    v_fma_f32 v240, v169, v244, v240
    v_fma_f32 v241, v168, v245, v241
    v_fma_f32 v242, v168, v246, v242
    v_fma_f32 v243, v168, v247, v243
    v_cvt_pk_bf16_f32 v170, v240, v241
    v_cvt_pk_bf16_f32 v171, v242, v243
    buffer_store_dwordx2 v[170:171], v66, s[48:51], s72 offen
    s_cmp_lg_u32 s22, 0
    s_cbranch_scc1 KA_S0_8
    v_cvt_pk_bf16_f32 v172, v244, v62
    s_mov_b64 s[70:71], exec
    s_mov_b64 exec, 0xffff
    buffer_store_dword v172, v67, s[48:51], s72 offen
    s_mov_b64 exec, s[70:71]
KA_S0_8:
    s_cmp_lg_u32 s19, 0
    s_cbranch_scc1 KA_END
    s_cmp_lg_u32 s21, 1
    s_cbranch_scc1 KA_END
    s_lshl_b32 s65, s20, 5
    v_add_u32 v65, s65, v0
    s_mov_b32 s66, 2176
    v_mul_lo_u32 v66, v65, s66
    v_add_u32 v66, 2052, v66
    v_cmp_gt_u32 vcc, 32, v0
    s_and_saveexec_b64 s[70:71], vcc
    buffer_store_dword v62, v66, s[48:51], 0 offen offset:0
    buffer_store_dword v62, v66, s[48:51], 0 offen offset:4
    buffer_store_dword v62, v66, s[48:51], 0 offen offset:8
    buffer_store_dword v62, v66, s[48:51], 0 offen offset:12
    buffer_store_dword v62, v66, s[48:51], 0 offen offset:16
    buffer_store_dword v62, v66, s[48:51], 0 offen offset:20
    buffer_store_dword v62, v66, s[48:51], 0 offen offset:24
    buffer_store_dword v62, v66, s[48:51], 0 offen offset:28
    buffer_store_dword v62, v66, s[48:51], 0 offen offset:32
    buffer_store_dword v62, v66, s[48:51], 0 offen offset:36
    buffer_store_dword v62, v66, s[48:51], 0 offen offset:40
    buffer_store_dword v62, v66, s[48:51], 0 offen offset:44
    buffer_store_dword v62, v66, s[48:51], 0 offen offset:48
    buffer_store_dword v62, v66, s[48:51], 0 offen offset:52
    buffer_store_dword v62, v66, s[48:51], 0 offen offset:56
    s_mov_b64 exec, s[70:71]
KA_END:
    s_endpgm
.globl fnet_kb_kernel
.p2align 8
.type fnet_kb_kernel,@function
fnet_kb_kernel:
    s_cmp_ge_u32 s2, 256
    s_cbranch_scc1 KB_END
    s_load_dwordx2 s[4:5], s[0:1], 0
    s_load_dwordx4 s[8:11], s[0:1], 8
    s_load_dwordx2 s[12:13], s[0:1], 64
    s_load_dwordx2 s[16:17], s[0:1], 80
    s_and_b32 s3, s2, 7
    s_lshr_b32 s18, s2, 3
    s_and_b32 s19, s3, 3
    s_lshl_b32 s19, s19, 3
    s_and_b32 s20, s18, 7
    s_add_u32 s19, s19, s20
    s_lshr_b32 s20, s3, 2
    s_lshl_b32 s20, s20, 2
    s_lshr_b32 s21, s18, 3
    s_add_u32 s20, s20, s21
    v_lshrrev_b32 v1, 6, v0
    v_and_b32 v0, 63, v0
    v_and_b32 v2, 15, v0
    v_readfirstlane_b32 s21, v1
    v_lshrrev_b32 v3, 4, v0
    s_mov_b32 s61, 3584
    s_mov_b32 s62, 2176
    s_lshl_b32 s52, s19, 5
    s_lshl_b32 s53, s20, 5
    s_sub_u32 s54, 2016, s52
    s_sub_u32 s55, 480, s53
    s_mul_i32 s56, s21, 896
    s_lshl_b32 s57, s21, 9
    v_lshlrev_b32 v4, 4, v3
    v_mov_b32 v8, 1073741824
    s_cmp_eq_u32 s21, 3
    s_cselect_b32 s58, 33, 0
    v_add_u32 v7, 0, v2
    v_add_u32 v9, s53, v7
    v_mul_lo_u32 v36, v9, s62
    v_add_u32 v38, 0x800, v36
    v_add_u32 v38, v38, v4
    v_cmp_gt_u32 vcc, s58, v7
    s_nop 1
    v_cndmask_b32 v30, v8, v38, vcc
    v_add_u32 v9, s52, v7
    v_lshlrev_b32 v36, 12, v9
    v_add_u32 v38, 0x800, v36
    v_add_u32 v38, v38, v4
    v_cndmask_b32 v33, v8, v38, vcc
    v_add_u32 v7, 16, v2
    v_add_u32 v9, s53, v7
    v_mul_lo_u32 v36, v9, s62
    v_add_u32 v38, 0x800, v36
    v_add_u32 v38, v38, v4
    v_cmp_gt_u32 vcc, s58, v7
    s_nop 1
    v_cndmask_b32 v31, v8, v38, vcc
    v_add_u32 v9, s52, v7
    v_lshlrev_b32 v36, 12, v9
    v_add_u32 v38, 0x800, v36
    v_add_u32 v38, v38, v4
    v_cndmask_b32 v34, v8, v38, vcc
    v_add_u32 v7, 32, v2
    v_add_u32 v9, s53, v7
    v_mul_lo_u32 v36, v9, s62
    v_add_u32 v38, 0x800, v36
    v_add_u32 v38, v38, v4
    v_cmp_gt_u32 vcc, s58, v7
    s_nop 1
    v_cndmask_b32 v32, v8, v38, vcc
    v_add_u32 v9, s52, v7
    v_lshlrev_b32 v36, 12, v9
    v_add_u32 v38, 0x800, v36
    v_add_u32 v38, v38, v4
    v_cndmask_b32 v35, v8, v38, vcc
    v_lshrrev_b32 v20, 3, v0
    v_lshrrev_b32 v21, 4, v0
    v_and_b32 v22, 7, v0
    v_and_b32 v23, 1, v21
    v_or_b32 v23, 0, v23
    v_xor_b32 v23, v22, v23
    v_add_u32 v24, 0, v20
    v_mul_lo_u32 v24, v24, s61
    v_lshl_add_u32 v10, v23, 4, v24
    v_and_b32 v23, 1, v21
    v_or_b32 v23, 2, v23
    v_xor_b32 v23, v22, v23
    v_add_u32 v24, 8, v20
    v_mul_lo_u32 v24, v24, s61
    v_lshl_add_u32 v11, v23, 4, v24
    v_and_b32 v23, 1, v21
    v_or_b32 v23, 4, v23
    v_xor_b32 v23, v22, v23
    v_add_u32 v24, 16, v20
    v_mul_lo_u32 v24, v24, s61
    v_lshl_add_u32 v12, v23, 4, v24
    v_and_b32 v23, 1, v21
    v_or_b32 v23, 6, v23
    v_xor_b32 v23, v22, v23
    v_add_u32 v24, 24, v20
    v_mul_lo_u32 v24, v24, s61
    v_lshl_add_u32 v13, v23, 4, v24
    v_xor_b32 v23, 0, v21
    v_xor_b32 v23, v22, v23
    v_lshlrev_b32 v23, 4, v23
    v_add_u32 v24, 0, v20
    v_mul_lo_u32 v25, v24, s61
    v_add_u32 v14, v25, v23
    v_lshl_add_u32 v16, v24, 12, v23
    v_mul_lo_u32 v25, v24, s62
    v_add_u32 v18, v25, v23
    v_sub_u32 v24, 15, v24
    v_mul_lo_u32 v25, v24, s62
    v_add_u32 v36, v25, v23
    v_xor_b32 v23, 4, v21
    v_xor_b32 v23, v22, v23
    v_lshlrev_b32 v23, 4, v23
    v_add_u32 v24, 8, v20
    v_mul_lo_u32 v25, v24, s61
    v_add_u32 v15, v25, v23
    v_lshl_add_u32 v17, v24, 12, v23
    v_mul_lo_u32 v25, v24, s62
    v_add_u32 v19, v25, v23
    v_sub_u32 v24, 15, v24
    v_mul_lo_u32 v25, v24, s62
    v_add_u32 v37, v25, v23
    s_mul_i32 s64, s53, s61
    s_add_u32 s64, s64, s56
    s_mul_i32 s65, s55, s61
    s_add_u32 s65, s65, s56
    s_mul_i32 s66, s52, s61
    s_add_u32 s66, s66, s56
    s_add_u32 s67, s66, 57344
    s_mul_i32 s68, s54, s61
    s_add_u32 s68, s68, s56
    s_add_u32 s69, s68, 57344
    s_lshl_b32 s70, s52, 12
    s_add_u32 s70, s70, s57
    s_add_u32 s71, s70, 65536
    s_mul_i32 s72, s53, s62
    s_add_u32 s72, s72, s57
    s_add_u32 s73, s72, 34816
    s_sub_u32 s74, 497, s53
    s_mul_i32 s74, s74, s62
    s_add_u32 s74, s74, s57
    s_sub_u32 s75, s74, 34816
    v_add_u32 v23, s57, v4
    s_add_u32 s59, s53, 32
    s_mul_i32 s60, s59, s62
    v_add_u32 v26, s60, v23
    s_sub_u32 s60, 512, s59
    s_mul_i32 s60, s60, s62
    s_cmp_eq_u32 s59, 256
    s_cselect_b32 s60, 1073741824, s60
    v_add_u32 v27, s60, v23
    s_add_u32 s59, s52, 32
    s_lshl_b32 s59, s59, 12
    v_add_u32 v28, s59, v23
    s_mul_i32 s63, s21, 30720
    v_lshrrev_b32 v23, 1, v2
    v_xor_b32 v23, v23, v3
    v_lshlrev_b32 v23, 4, v23
    v_lshl_add_u32 v23, v2, 7, v23
    v_add_u32 v40, s63, v23
    v_xor_b32 v41, 64, v40
    v_lshrrev_b32 v23, 2, v2
    v_and_b32 v24, 3, v2
    v_lshl_add_u32 v25, v23, 3, v24
    v_lshrrev_b32 v24, 1, v24
    v_lshl_add_u32 v24, v23, 1, v24
    v_xor_b32 v24, v24, v3
    v_lshlrev_b32 v24, 4, v24
    v_lshl_add_u32 v24, v25, 7, v24
    v_add_u32 v42, s63, v24
    v_xor_b32 v43, 64, v42
    s_waitcnt lgkmcnt(0)
    s_add_u32 s40, s16, 8388608
    s_addc_u32 s41, s17, 0
    s_and_b32 s41, s41, 0xffff
    s_mov_b32 s42, 1114112
    s_mov_b32 s43, 0x00020000
    s_mov_b32 s44, s8
    s_mov_b32 s45, s9
    s_and_b32 s45, s45, 0xffff
    s_mov_b32 s46, 8388608
    s_mov_b32 s47, 0x00020000
    s_mov_b32 s48, s10
    s_mov_b32 s49, s11
    s_and_b32 s49, s49, 0xffff
    s_mov_b32 s50, 8388608
    s_mov_b32 s51, 0x00020000
    s_mov_b32 s32, s16
    s_mov_b32 s33, s17
    s_and_b32 s33, s33, 0xffff
    s_mov_b32 s34, 7340032
    s_mov_b32 s35, 0x00020000
    s_add_u32 s36, s16, 10485760
    s_addc_u32 s37, s17, 0
    s_and_b32 s37, s37, 0xffff
    s_mov_b32 s38, 1835008
    s_mov_b32 s39, 0x00020000
    s_mov_b32 s24, s4
    s_mov_b32 s25, s5
    s_and_b32 s25, s25, 0xffff
    s_mov_b32 s26, 2097152
    s_mov_b32 s27, 0x00020000
    s_mov_b32 s28, s12
    s_mov_b32 s29, s13
    s_and_b32 s29, s29, 0xffff
    s_mov_b32 s30, 2097152
    s_mov_b32 s31, 0x00020000
    buffer_load_dwordx4 v[160:163], v30, s[40:43], 0 offen
    buffer_load_dwordx4 v[164:167], v31, s[40:43], 0 offen
    buffer_load_dwordx4 v[168:171], v32, s[40:43], 0 offen
    buffer_load_dwordx4 v[172:175], v33, s[44:47], 0 offen
    buffer_load_dwordx4 v[176:179], v34, s[44:47], 0 offen
    buffer_load_dwordx4 v[180:183], v35, s[44:47], 0 offen
    s_add_u32 m0, s63, 0
    s_add_u32 s76, s72, 0
    buffer_load_dwordx4 v18, s[40:43], s76 offen lds
    s_add_u32 m0, s63, 1024
    s_nop 0
    buffer_load_dwordx4 v19, s[40:43], s76 offen lds
    s_add_u32 m0, s63, 2048
    s_add_u32 s76, s73, 0
    buffer_load_dwordx4 v18, s[40:43], s76 offen lds
    s_add_u32 m0, s63, 3072
    s_nop 0
    buffer_load_dwordx4 v19, s[40:43], s76 offen lds
    s_add_u32 m0, s63, 4096
    s_add_u32 s76, s70, 0
    buffer_load_dwordx4 v16, s[44:47], s76 offen lds
    s_add_u32 m0, s63, 5120
    s_nop 0
    buffer_load_dwordx4 v17, s[44:47], s76 offen lds
    s_add_u32 m0, s63, 6144
    s_add_u32 s76, s71, 0
    buffer_load_dwordx4 v16, s[44:47], s76 offen lds
    s_add_u32 m0, s63, 7168
    s_nop 0
    buffer_load_dwordx4 v17, s[44:47], s76 offen lds
    s_add_u32 m0, s63, 8192
    s_add_u32 s76, s74, 0
    buffer_load_dwordx4 v36, s[40:43], s76 offen lds
    s_add_u32 m0, s63, 9216
    s_nop 0
    buffer_load_dwordx4 v37, s[40:43], s76 offen lds
    s_add_u32 m0, s63, 10240
    s_add_u32 s76, s75, 0
    buffer_load_dwordx4 v36, s[40:43], s76 offen lds
    s_add_u32 m0, s63, 11264
    s_nop 0
    buffer_load_dwordx4 v37, s[40:43], s76 offen lds
    s_add_u32 m0, s63, 12288
    s_add_u32 s76, s70, 0
    buffer_load_dwordx4 v16, s[48:51], s76 offen lds
    s_add_u32 m0, s63, 13312
    s_nop 0
    buffer_load_dwordx4 v17, s[48:51], s76 offen lds
    s_add_u32 m0, s63, 14336
    s_add_u32 s76, s71, 0
    buffer_load_dwordx4 v16, s[48:51], s76 offen lds
    s_add_u32 m0, s63, 15360
    s_nop 0
    buffer_load_dwordx4 v17, s[48:51], s76 offen lds
    s_add_u32 m0, s63, 16384
    s_add_u32 s76, s72, 128
    buffer_load_dwordx4 v18, s[40:43], s76 offen lds
    s_add_u32 m0, s63, 17408
    s_nop 0
    buffer_load_dwordx4 v19, s[40:43], s76 offen lds
    s_add_u32 m0, s63, 18432
    s_add_u32 s76, s73, 128
    buffer_load_dwordx4 v18, s[40:43], s76 offen lds
    s_add_u32 m0, s63, 19456
    s_nop 0
    buffer_load_dwordx4 v19, s[40:43], s76 offen lds
    s_add_u32 m0, s63, 20480
    s_add_u32 s76, s70, 128
    buffer_load_dwordx4 v16, s[44:47], s76 offen lds
    s_add_u32 m0, s63, 21504
    s_nop 0
    buffer_load_dwordx4 v17, s[44:47], s76 offen lds
    s_add_u32 m0, s63, 22528
    s_add_u32 s76, s71, 128
    buffer_load_dwordx4 v16, s[44:47], s76 offen lds
    s_add_u32 m0, s63, 23552
    s_nop 0
    buffer_load_dwordx4 v17, s[44:47], s76 offen lds
    s_add_u32 m0, s63, 24576
    s_add_u32 s76, s74, 128
    buffer_load_dwordx4 v36, s[40:43], s76 offen lds
    s_add_u32 m0, s63, 25600
    s_nop 0
    buffer_load_dwordx4 v37, s[40:43], s76 offen lds
    s_add_u32 m0, s63, 26624
    s_add_u32 s76, s75, 128
    buffer_load_dwordx4 v36, s[40:43], s76 offen lds
    s_add_u32 m0, s63, 27648
    s_nop 0
    buffer_load_dwordx4 v37, s[40:43], s76 offen lds
    s_add_u32 m0, s63, 28672
    s_add_u32 s76, s70, 128
    buffer_load_dwordx4 v16, s[48:51], s76 offen lds
    s_add_u32 m0, s63, 29696
    s_nop 0
    buffer_load_dwordx4 v17, s[48:51], s76 offen lds
    buffer_load_dwordx4 v[128:131], v26, s[40:43], 0 offen offset:0
    buffer_load_dwordx4 v[132:135], v26, s[40:43], 0 offen offset:64
    buffer_load_dwordx4 v[136:139], v28, s[44:47], 0 offen offset:0
    buffer_load_dwordx4 v[140:143], v28, s[44:47], 0 offen offset:64
    buffer_load_dwordx4 v[144:147], v27, s[40:43], 0 offen offset:0
    buffer_load_dwordx4 v[148:151], v27, s[40:43], 0 offen offset:64
    buffer_load_dwordx4 v[152:155], v28, s[48:51], 0 offen offset:0
    buffer_load_dwordx4 v[156:159], v28, s[48:51], 0 offen offset:64
    v_accvgpr_write_b32 a0, 0
    v_accvgpr_write_b32 a1, 0
    v_accvgpr_write_b32 a2, 0
    v_accvgpr_write_b32 a3, 0
    v_accvgpr_write_b32 a4, 0
    v_accvgpr_write_b32 a5, 0
    v_accvgpr_write_b32 a6, 0
    v_accvgpr_write_b32 a7, 0
    v_accvgpr_write_b32 a8, 0
    v_accvgpr_write_b32 a9, 0
    v_accvgpr_write_b32 a10, 0
    v_accvgpr_write_b32 a11, 0
    v_accvgpr_write_b32 a12, 0
    v_accvgpr_write_b32 a13, 0
    v_accvgpr_write_b32 a14, 0
    v_accvgpr_write_b32 a15, 0
    v_accvgpr_write_b32 a16, 0
    v_accvgpr_write_b32 a17, 0
    v_accvgpr_write_b32 a18, 0
    v_accvgpr_write_b32 a19, 0
    v_accvgpr_write_b32 a20, 0
    v_accvgpr_write_b32 a21, 0
    v_accvgpr_write_b32 a22, 0
    v_accvgpr_write_b32 a23, 0
    v_accvgpr_write_b32 a24, 0
    v_accvgpr_write_b32 a25, 0
    v_accvgpr_write_b32 a26, 0
    v_accvgpr_write_b32 a27, 0
    v_accvgpr_write_b32 a28, 0
    v_accvgpr_write_b32 a29, 0
    v_accvgpr_write_b32 a30, 0
    v_accvgpr_write_b32 a31, 0
    v_accvgpr_write_b32 a32, 0
    v_accvgpr_write_b32 a33, 0
    v_accvgpr_write_b32 a34, 0
    v_accvgpr_write_b32 a35, 0
    v_accvgpr_write_b32 a36, 0
    v_accvgpr_write_b32 a37, 0
    v_accvgpr_write_b32 a38, 0
    v_accvgpr_write_b32 a39, 0
    v_accvgpr_write_b32 a40, 0
    v_accvgpr_write_b32 a41, 0
    v_accvgpr_write_b32 a42, 0
    v_accvgpr_write_b32 a43, 0
    v_accvgpr_write_b32 a44, 0
    v_accvgpr_write_b32 a45, 0
    v_accvgpr_write_b32 a46, 0
    v_accvgpr_write_b32 a47, 0
    v_accvgpr_write_b32 a48, 0
    v_accvgpr_write_b32 a49, 0
    v_accvgpr_write_b32 a50, 0
    v_accvgpr_write_b32 a51, 0
    v_accvgpr_write_b32 a52, 0
    v_accvgpr_write_b32 a53, 0
    v_accvgpr_write_b32 a54, 0
    v_accvgpr_write_b32 a55, 0
    v_accvgpr_write_b32 a56, 0
    v_accvgpr_write_b32 a57, 0
    v_accvgpr_write_b32 a58, 0
    v_accvgpr_write_b32 a59, 0
    v_accvgpr_write_b32 a60, 0
    v_accvgpr_write_b32 a61, 0
    v_accvgpr_write_b32 a62, 0
    v_accvgpr_write_b32 a63, 0
    v_accvgpr_write_b32 a64, 0
    v_accvgpr_write_b32 a65, 0
    v_accvgpr_write_b32 a66, 0
    v_accvgpr_write_b32 a67, 0
    v_accvgpr_write_b32 a68, 0
    v_accvgpr_write_b32 a69, 0
    v_accvgpr_write_b32 a70, 0
    v_accvgpr_write_b32 a71, 0
    v_accvgpr_write_b32 a72, 0
    v_accvgpr_write_b32 a73, 0
    v_accvgpr_write_b32 a74, 0
    v_accvgpr_write_b32 a75, 0
    v_accvgpr_write_b32 a76, 0
    v_accvgpr_write_b32 a77, 0
    v_accvgpr_write_b32 a78, 0
    v_accvgpr_write_b32 a79, 0
    v_accvgpr_write_b32 a80, 0
    v_accvgpr_write_b32 a81, 0
    v_accvgpr_write_b32 a82, 0
    v_accvgpr_write_b32 a83, 0
    v_accvgpr_write_b32 a84, 0
    v_accvgpr_write_b32 a85, 0
    v_accvgpr_write_b32 a86, 0
    v_accvgpr_write_b32 a87, 0
    v_accvgpr_write_b32 a88, 0
    v_accvgpr_write_b32 a89, 0
    v_accvgpr_write_b32 a90, 0
    v_accvgpr_write_b32 a91, 0
    v_accvgpr_write_b32 a92, 0
    v_accvgpr_write_b32 a93, 0
    v_accvgpr_write_b32 a94, 0
    v_accvgpr_write_b32 a95, 0
    v_accvgpr_write_b32 a96, 0
    v_accvgpr_write_b32 a97, 0
    v_accvgpr_write_b32 a98, 0
    v_accvgpr_write_b32 a99, 0
    v_accvgpr_write_b32 a100, 0
    v_accvgpr_write_b32 a101, 0
    v_accvgpr_write_b32 a102, 0
    v_accvgpr_write_b32 a103, 0
    v_accvgpr_write_b32 a104, 0
    v_accvgpr_write_b32 a105, 0
    v_accvgpr_write_b32 a106, 0
    v_accvgpr_write_b32 a107, 0
    v_accvgpr_write_b32 a108, 0
    v_accvgpr_write_b32 a109, 0
    v_accvgpr_write_b32 a110, 0
    v_accvgpr_write_b32 a111, 0
    v_accvgpr_write_b32 a112, 0
    v_accvgpr_write_b32 a113, 0
    v_accvgpr_write_b32 a114, 0
    v_accvgpr_write_b32 a115, 0
    v_accvgpr_write_b32 a116, 0
    v_accvgpr_write_b32 a117, 0
    v_accvgpr_write_b32 a118, 0
    v_accvgpr_write_b32 a119, 0
    v_accvgpr_write_b32 a120, 0
    v_accvgpr_write_b32 a121, 0
    v_accvgpr_write_b32 a122, 0
    v_accvgpr_write_b32 a123, 0
    v_accvgpr_write_b32 a124, 0
    v_accvgpr_write_b32 a125, 0
    v_accvgpr_write_b32 a126, 0
    v_accvgpr_write_b32 a127, 0
    v_accvgpr_write_b32 a128, 0
    v_accvgpr_write_b32 a129, 0
    v_accvgpr_write_b32 a130, 0
    v_accvgpr_write_b32 a131, 0
    v_accvgpr_write_b32 a132, 0
    v_accvgpr_write_b32 a133, 0
    v_accvgpr_write_b32 a134, 0
    v_accvgpr_write_b32 a135, 0
    v_mul_u32_u24 v49, 144, v2
    v_lshl_add_u32 v49, v3, 4, v49
    s_mul_i32 s59, s21, 9504
    s_add_u32 s59, s59, 122880
    v_add_u32 v49, s59, v49
    s_and_b32 s77, s21, 1
    s_lshr_b32 s78, s21, 1
    s_cmp_eq_u32 s77, 0
    s_cselect_b32 s22, s53, s55
    s_cmp_eq_u32 s78, 0
    s_cselect_b32 s23, s52, s54
    v_add_u32 v46, s23, v2
    v_lshlrev_b32 v46, 10, v46
    v_lshl_add_u32 v46, v3, 4, v46
    s_lshl_b32 s22, s22, 1
    v_add_u32 v46, s22, v46
    v_add_u32 v47, 0x4000, v46
    s_xor_b32 s59, s77, s78
    s_mul_i32 s59, s59, 4752
    s_add_u32 s59, s59, 122880
    v_lshlrev_b32 v44, 3, v3
    v_sub_u32 v45, 25, v44
    s_cmp_eq_u32 s77, 0
    s_cselect_b64 vcc, -1, 0
    v_cndmask_b32 v44, v45, v44, vcc
    v_sub_u32 v45, 32, v2
    s_cmp_eq_u32 s78, 0
    s_cselect_b64 vcc, -1, 0
    v_cndmask_b32 v45, v45, v2, vcc
    v_mul_u32_u24 v45, 144, v45
    v_lshl_add_u32 v44, v44, 2, v45
    v_add_u32 v44, s59, v44
    s_mov_b32 s22, 2304
    s_mov_b32 s23, -2304
    s_cmp_eq_u32 s78, 0
    s_cselect_b32 s59, s22, s23
    v_add_u32 v45, s59, v44
    s_and_b32 s59, s20, 7
    s_cmp_eq_u32 s59, 0
    s_cselect_b64 s[58:59], 0xffff, 0
    v_mov_b32 v39, 0
    s_mov_b32 s56, 0x00010001
    s_mov_b32 s57, 0x00010001
    v_lshlrev_b32 v48, 4, v0
    v_add_u32 v50, s63, v48
    s_sub_u32 s22, s21, 1
    s_and_b32 s22, s22, 3
    s_mul_i32 s22, s22, 30720
    v_add_u32 v51, s22, v48
    s_sub_u32 s22, s21, 2
    s_and_b32 s22, s22, 3
    s_mul_i32 s22, s22, 30720
    v_add_u32 v52, s22, v48
    s_sub_u32 s22, s21, 3
    s_and_b32 s22, s22, 3
    s_mul_i32 s22, s22, 30720
    v_add_u32 v53, s22, v48
    s_waitcnt vmcnt(38)
    v_mfma_f32_16x16x32_bf16 a[64:67], v[160:163], v[172:175], a[64:67]
    s_waitcnt vmcnt(36)
    ds_read_b128 v[64:67], v40 offset:0
    ds_read_b128 v[68:71], v41 offset:0
    s_waitcnt vmcnt(34)
    ds_read_b128 v[72:75], v40 offset:2048
    ds_read_b128 v[76:79], v41 offset:2048
    s_waitcnt vmcnt(32)
    ds_read_b128 v[80:83], v40 offset:4096
    ds_read_b128 v[84:87], v41 offset:4096
    v_mfma_f32_16x16x32_bf16 a[68:71], v[160:163], v[176:179], a[68:71]
    s_waitcnt lgkmcnt(4)
    s_add_u32 m0, s63, 0
    s_add_u32 s76, s71, 128
    buffer_load_dwordx4 v16, s[48:51], s76 offen lds
    s_add_u32 m0, s63, 1024
    s_nop 0
    buffer_load_dwordx4 v17, s[48:51], s76 offen lds
    s_waitcnt vmcnt(32)
    ds_read_b128 v[88:91], v40 offset:6144
    v_mfma_f32_16x16x32_bf16 a[72:75], v[160:163], v[180:183], a[72:75]
    ds_read_b128 v[92:95], v41 offset:6144
    s_waitcnt lgkmcnt(4)
    s_add_u32 m0, s63, 2048
    s_add_u32 s76, s72, 256
    buffer_load_dwordx4 v18, s[40:43], s76 offen lds
    s_add_u32 m0, s63, 3072
    s_nop 0
    buffer_load_dwordx4 v19, s[40:43], s76 offen lds
    s_waitcnt vmcnt(32)
    v_mfma_f32_16x16x32_bf16 a[76:79], v[164:167], v[172:175], a[76:79]
    ds_read_b128 v[96:99], v40 offset:8192
    ds_read_b128 v[100:103], v41 offset:8192
    s_waitcnt lgkmcnt(4)
    s_add_u32 m0, s63, 4096
    s_add_u32 s76, s73, 256
    buffer_load_dwordx4 v18, s[40:43], s76 offen lds
    s_add_u32 m0, s63, 5120
    s_nop 0
    buffer_load_dwordx4 v19, s[40:43], s76 offen lds
    v_mfma_f32_16x16x32_bf16 a[80:83], v[164:167], v[176:179], a[80:83]
    s_waitcnt vmcnt(32)
    ds_read_b128 v[104:107], v40 offset:10240
    ds_read_b128 v[108:111], v41 offset:10240
    s_waitcnt lgkmcnt(4)
    s_add_u32 m0, s63, 6144
    s_add_u32 s76, s70, 256
    buffer_load_dwordx4 v16, s[44:47], s76 offen lds
    s_add_u32 m0, s63, 7168
    v_mfma_f32_16x16x32_bf16 a[84:87], v[164:167], v[180:183], a[84:87]
    buffer_load_dwordx4 v17, s[44:47], s76 offen lds
    s_waitcnt vmcnt(32)
    ds_read_b128 v[112:115], v40 offset:12288
    ds_read_b128 v[116:119], v41 offset:12288
    s_waitcnt lgkmcnt(4)
    s_add_u32 m0, s63, 8192
    s_add_u32 s76, s71, 256
    buffer_load_dwordx4 v16, s[44:47], s76 offen lds
    s_add_u32 m0, s63, 9216
    v_mfma_f32_16x16x32_bf16 a[88:91], v[168:171], v[172:175], a[88:91]
    buffer_load_dwordx4 v17, s[44:47], s76 offen lds
    s_waitcnt vmcnt(32)
    ds_read_b128 v[120:123], v40 offset:14336
    ds_read_b128 v[124:127], v41 offset:14336
    s_waitcnt lgkmcnt(4)
    s_add_u32 m0, s63, 10240
    s_add_u32 s76, s74, 256
    v_mfma_f32_16x16x32_bf16 a[92:95], v[168:171], v[176:179], a[92:95]
    buffer_load_dwordx4 v36, s[40:43], s76 offen lds
    s_add_u32 m0, s63, 11264
    s_nop 0
    buffer_load_dwordx4 v37, s[40:43], s76 offen lds
    s_waitcnt lgkmcnt(2)
    s_add_u32 m0, s63, 12288
    s_add_u32 s76, s75, 256
    buffer_load_dwordx4 v36, s[40:43], s76 offen lds
    s_add_u32 m0, s63, 13312
    v_mfma_f32_16x16x32_bf16 a[96:99], v[168:171], v[180:183], a[96:99]
    buffer_load_dwordx4 v37, s[40:43], s76 offen lds
    s_waitcnt lgkmcnt(0)
    s_add_u32 m0, s63, 14336
    s_add_u32 s76, s70, 256
    buffer_load_dwordx4 v16, s[48:51], s76 offen lds
    s_add_u32 m0, s63, 15360
    s_nop 0
    buffer_load_dwordx4 v17, s[48:51], s76 offen lds
    s_waitcnt lgkmcnt(0)
    buffer_load_dwordx4 v[224:227], v26, s[40:43], 0 offen offset:128
    buffer_load_dwordx4 v[228:231], v26, s[40:43], 0 offen offset:192
    buffer_load_dwordx4 v[232:235], v28, s[44:47], 0 offen offset:128
    buffer_load_dwordx4 v[236:239], v28, s[44:47], 0 offen offset:192
    buffer_load_dwordx4 v[240:243], v27, s[40:43], 0 offen offset:128
    buffer_load_dwordx4 v[244:247], v27, s[40:43], 0 offen offset:192
    buffer_load_dwordx4 v[248:251], v28, s[48:51], 0 offen offset:128
    buffer_load_dwordx4 v[252:255], v28, s[48:51], 0 offen offset:192
    v_mfma_f32_16x16x32_bf16 a[64:67], v[64:67], v[80:83], a[64:67]
    s_waitcnt vmcnt(44)
    ds_read_b128 v[160:163], v40 offset:16384
    ds_read_b128 v[164:167], v41 offset:16384
    v_mfma_f32_16x16x32_bf16 a[68:71], v[64:67], v[88:91], a[68:71]
    s_waitcnt vmcnt(42)
    ds_read_b128 v[168:171], v40 offset:18432
    v_mfma_f32_16x16x32_bf16 a[76:79], v[72:75], v[80:83], a[76:79]
    ds_read_b128 v[172:175], v41 offset:18432
    s_waitcnt vmcnt(40)
    v_mfma_f32_16x16x32_bf16 a[80:83], v[72:75], v[88:91], a[80:83]
    ds_read_b128 v[176:179], v40 offset:20480
    ds_read_b128 v[180:183], v41 offset:20480
    v_mfma_f32_16x16x32_bf16 a[100:103], v[96:99], v[112:115], a[100:103]
    s_waitcnt lgkmcnt(4)
    s_add_u32 m0, s63, 16384
    s_add_u32 s76, s71, 256
    v_mfma_f32_16x16x32_bf16 a[104:107], v[96:99], v[120:123], a[104:107]
    buffer_load_dwordx4 v16, s[48:51], s76 offen lds
    s_add_u32 m0, s63, 17408
    v_mfma_f32_16x16x32_bf16 a[112:115], v[104:107], v[112:115], a[112:115]
    buffer_load_dwordx4 v17, s[48:51], s76 offen lds
    v_mfma_f32_16x16x32_bf16 a[116:119], v[104:107], v[120:123], a[116:119]
    s_waitcnt vmcnt(40)
    ds_read_b128 v[184:187], v40 offset:22528
    v_mfma_f32_16x16x32_bf16 a[64:67], v[68:71], v[84:87], a[64:67]
    ds_read_b128 v[188:191], v41 offset:22528
    s_waitcnt lgkmcnt(4)
    v_mfma_f32_16x16x32_bf16 a[68:71], v[68:71], v[92:95], a[68:71]
    s_add_u32 m0, s63, 18432
    s_add_u32 s76, s72, 384
    v_mfma_f32_16x16x32_bf16 a[76:79], v[76:79], v[84:87], a[76:79]
    buffer_load_dwordx4 v18, s[40:43], s76 offen lds
    s_add_u32 m0, s63, 19456
    v_mfma_f32_16x16x32_bf16 a[80:83], v[76:79], v[92:95], a[80:83]
    buffer_load_dwordx4 v19, s[40:43], s76 offen lds
    s_waitcnt vmcnt(40)
    v_mfma_f32_16x16x32_bf16 a[100:103], v[100:103], v[116:119], a[100:103]
    ds_read_b128 v[192:195], v40 offset:24576
    ds_read_b128 v[196:199], v41 offset:24576
    v_mfma_f32_16x16x32_bf16 a[104:107], v[100:103], v[124:127], a[104:107]
    s_waitcnt lgkmcnt(4)
    s_add_u32 m0, s63, 20480
    s_add_u32 s76, s73, 384
    v_mfma_f32_16x16x32_bf16 a[112:115], v[108:111], v[116:119], a[112:115]
    buffer_load_dwordx4 v18, s[40:43], s76 offen lds
    s_add_u32 m0, s63, 21504
    v_mfma_f32_16x16x32_bf16 a[116:119], v[108:111], v[124:127], a[116:119]
    buffer_load_dwordx4 v19, s[40:43], s76 offen lds
    s_waitcnt vmcnt(30)
    v_mfma_f32_16x16x32_bf16 a[72:75], v[64:67], v[136:139], a[72:75]
    s_waitcnt vmcnt(40)
    ds_read_b128 v[200:203], v40 offset:26624
    v_mfma_f32_16x16x32_bf16 a[84:87], v[72:75], v[136:139], a[84:87]
    ds_read_b128 v[204:207], v41 offset:26624
    s_waitcnt lgkmcnt(4)
    v_mfma_f32_16x16x32_bf16 a[88:91], v[128:131], v[80:83], a[88:91]
    s_add_u32 m0, s63, 22528
    s_add_u32 s76, s70, 384
    v_mfma_f32_16x16x32_bf16 a[92:95], v[128:131], v[88:91], a[92:95]
    buffer_load_dwordx4 v16, s[44:47], s76 offen lds
    s_add_u32 m0, s63, 23552
    v_mfma_f32_16x16x32_bf16 a[96:99], v[128:131], v[136:139], a[96:99]
    buffer_load_dwordx4 v17, s[44:47], s76 offen lds
    s_waitcnt vmcnt(40)
    v_mfma_f32_16x16x32_bf16 a[108:111], v[96:99], v[152:155], a[108:111]
    ds_read_b128 v[208:211], v40 offset:28672
    ds_read_b128 v[212:215], v41 offset:28672
    v_mfma_f32_16x16x32_bf16 a[120:123], v[104:107], v[152:155], a[120:123]
    s_waitcnt lgkmcnt(4)
    s_add_u32 m0, s63, 24576
    s_add_u32 s76, s71, 384
    v_mfma_f32_16x16x32_bf16 a[124:127], v[144:147], v[112:115], a[124:127]
    buffer_load_dwordx4 v16, s[44:47], s76 offen lds
    s_add_u32 m0, s63, 25600
    v_mfma_f32_16x16x32_bf16 a[128:131], v[144:147], v[120:123], a[128:131]
    buffer_load_dwordx4 v17, s[44:47], s76 offen lds
    v_mfma_f32_16x16x32_bf16 a[132:135], v[144:147], v[152:155], a[132:135]
    s_waitcnt vmcnt(32)
    ds_read_b128 v[216:219], v40 offset:0
    v_mfma_f32_16x16x32_bf16 a[72:75], v[68:71], v[140:143], a[72:75]
    ds_read_b128 v[220:223], v41 offset:0
    s_waitcnt lgkmcnt(4)
    v_mfma_f32_16x16x32_bf16 a[84:87], v[76:79], v[140:143], a[84:87]
    s_add_u32 m0, s63, 26624
    s_add_u32 s76, s74, 384
    v_mfma_f32_16x16x32_bf16 a[88:91], v[132:135], v[84:87], a[88:91]
    buffer_load_dwordx4 v36, s[40:43], s76 offen lds
    s_add_u32 m0, s63, 27648
    v_mfma_f32_16x16x32_bf16 a[92:95], v[132:135], v[92:95], a[92:95]
    buffer_load_dwordx4 v37, s[40:43], s76 offen lds
    s_waitcnt lgkmcnt(2)
    v_mfma_f32_16x16x32_bf16 a[96:99], v[132:135], v[140:143], a[96:99]
    s_add_u32 m0, s63, 28672
    s_add_u32 s76, s75, 384
    v_mfma_f32_16x16x32_bf16 a[108:111], v[100:103], v[156:159], a[108:111]
    buffer_load_dwordx4 v36, s[40:43], s76 offen lds
    s_add_u32 m0, s63, 29696
    v_mfma_f32_16x16x32_bf16 a[120:123], v[108:111], v[156:159], a[120:123]
    buffer_load_dwordx4 v37, s[40:43], s76 offen lds
    s_waitcnt lgkmcnt(0)
    v_mfma_f32_16x16x32_bf16 a[124:127], v[148:151], v[116:119], a[124:127]
    s_add_u32 m0, s63, 0
    s_add_u32 s76, s70, 384
    v_mfma_f32_16x16x32_bf16 a[128:131], v[148:151], v[124:127], a[128:131]
    buffer_load_dwordx4 v16, s[48:51], s76 offen lds
    s_add_u32 m0, s63, 1024
    v_mfma_f32_16x16x32_bf16 a[132:135], v[148:151], v[156:159], a[132:135]
    buffer_load_dwordx4 v17, s[48:51], s76 offen lds
    s_waitcnt lgkmcnt(0)
    buffer_load_dwordx4 v[128:131], v26, s[40:43], 0 offen offset:256
    buffer_load_dwordx4 v[132:135], v26, s[40:43], 0 offen offset:320
    buffer_load_dwordx4 v[136:139], v28, s[44:47], 0 offen offset:256
    buffer_load_dwordx4 v[140:143], v28, s[44:47], 0 offen offset:320
    buffer_load_dwordx4 v[144:147], v27, s[40:43], 0 offen offset:256
    buffer_load_dwordx4 v[148:151], v27, s[40:43], 0 offen offset:320
    buffer_load_dwordx4 v[152:155], v28, s[48:51], 0 offen offset:256
    buffer_load_dwordx4 v[156:159], v28, s[48:51], 0 offen offset:320
    v_mfma_f32_16x16x32_bf16 a[64:67], v[160:163], v[176:179], a[64:67]
    s_waitcnt vmcnt(44)
    ds_read_b128 v[64:67], v40 offset:2048
    v_mfma_f32_16x16x32_bf16 a[68:71], v[160:163], v[184:187], a[68:71]
    ds_read_b128 v[68:71], v41 offset:2048
    s_waitcnt vmcnt(42)
    v_mfma_f32_16x16x32_bf16 a[76:79], v[168:171], v[176:179], a[76:79]
    ds_read_b128 v[72:75], v40 offset:4096
    ds_read_b128 v[76:79], v41 offset:4096
    v_mfma_f32_16x16x32_bf16 a[80:83], v[168:171], v[184:187], a[80:83]
    s_waitcnt vmcnt(40)
    ds_read_b128 v[80:83], v40 offset:6144
    v_mfma_f32_16x16x32_bf16 a[100:103], v[192:195], v[208:211], a[100:103]
    ds_read_b128 v[84:87], v41 offset:6144
    s_waitcnt lgkmcnt(4)
    v_mfma_f32_16x16x32_bf16 a[104:107], v[192:195], v[216:219], a[104:107]
    s_add_u32 m0, s63, 2048
    s_add_u32 s76, s71, 384
    v_mfma_f32_16x16x32_bf16 a[112:115], v[200:203], v[208:211], a[112:115]
    buffer_load_dwordx4 v16, s[48:51], s76 offen lds
    s_add_u32 m0, s63, 3072
    v_mfma_f32_16x16x32_bf16 a[116:119], v[200:203], v[216:219], a[116:119]
    buffer_load_dwordx4 v17, s[48:51], s76 offen lds
    s_waitcnt vmcnt(40)
    v_mfma_f32_16x16x32_bf16 a[64:67], v[164:167], v[180:183], a[64:67]
    ds_read_b128 v[88:91], v40 offset:8192
    ds_read_b128 v[92:95], v41 offset:8192
    v_mfma_f32_16x16x32_bf16 a[68:71], v[164:167], v[188:191], a[68:71]
    s_waitcnt vmcnt(38)
    ds_read_b128 v[96:99], v40 offset:10240
    v_mfma_f32_16x16x32_bf16 a[76:79], v[172:175], v[180:183], a[76:79]
    ds_read_b128 v[100:103], v41 offset:10240
    s_waitcnt lgkmcnt(4)
    v_mfma_f32_16x16x32_bf16 a[80:83], v[172:175], v[188:191], a[80:83]
    s_add_u32 m0, s63, 4096
    s_add_u32 s76, s64, 0
    v_mfma_f32_16x16x32_bf16 a[100:103], v[196:199], v[212:215], a[100:103]
    buffer_load_dwordx4 v10, s[36:39], s76 offen lds
    s_add_u32 m0, s63, 5120
    v_mfma_f32_16x16x32_bf16 a[104:107], v[196:199], v[220:223], a[104:107]
    buffer_load_dwordx4 v11, s[36:39], s76 offen lds
    s_add_u32 m0, s63, 6144
    v_mfma_f32_16x16x32_bf16 a[112:115], v[204:207], v[212:215], a[112:115]
    buffer_load_dwordx4 v12, s[36:39], s76 offen lds
    s_add_u32 m0, s63, 7168
    v_mfma_f32_16x16x32_bf16 a[116:119], v[204:207], v[220:223], a[116:119]
    buffer_load_dwordx4 v13, s[36:39], s76 offen lds
    s_waitcnt vmcnt(30)
    v_mfma_f32_16x16x32_bf16 a[72:75], v[160:163], v[232:235], a[72:75]
    s_waitcnt vmcnt(40)
    ds_read_b128 v[104:107], v40 offset:12288
    v_mfma_f32_16x16x32_bf16 a[84:87], v[168:171], v[232:235], a[84:87]
    ds_read_b128 v[108:111], v41 offset:12288
    s_waitcnt vmcnt(38)
    v_mfma_f32_16x16x32_bf16 a[88:91], v[224:227], v[176:179], a[88:91]
    ds_read_b128 v[112:115], v40 offset:14336
    ds_read_b128 v[116:119], v41 offset:14336
    v_mfma_f32_16x16x32_bf16 a[92:95], v[224:227], v[184:187], a[92:95]
    s_waitcnt lgkmcnt(4)
    s_add_u32 m0, s63, 8192
    s_add_u32 s76, s65, 0
    v_mfma_f32_16x16x32_bf16 a[96:99], v[224:227], v[232:235], a[96:99]
    buffer_load_dwordx4 v10, s[36:39], s76 offen lds
    s_add_u32 m0, s63, 9216
    v_mfma_f32_16x16x32_bf16 a[108:111], v[192:195], v[248:251], a[108:111]
    buffer_load_dwordx4 v11, s[36:39], s76 offen lds
    s_add_u32 m0, s63, 10240
    v_mfma_f32_16x16x32_bf16 a[120:123], v[200:203], v[248:251], a[120:123]
    buffer_load_dwordx4 v12, s[36:39], s76 offen lds
    s_add_u32 m0, s63, 11264
    v_mfma_f32_16x16x32_bf16 a[124:127], v[240:243], v[208:211], a[124:127]
    buffer_load_dwordx4 v13, s[36:39], s76 offen lds
    v_mfma_f32_16x16x32_bf16 a[128:131], v[240:243], v[216:219], a[128:131]
    s_waitcnt vmcnt(32)
    v_mfma_f32_16x16x32_bf16 a[132:135], v[240:243], v[248:251], a[132:135]
    ds_read_b128 v[120:123], v40 offset:16384
    ds_read_b128 v[124:127], v41 offset:16384
    v_mfma_f32_16x16x32_bf16 a[72:75], v[164:167], v[236:239], a[72:75]
    s_waitcnt lgkmcnt(4)
    s_add_u32 m0, s63, 12288
    s_add_u32 s76, s66, 0
    v_mfma_f32_16x16x32_bf16 a[84:87], v[172:175], v[236:239], a[84:87]
    buffer_load_dwordx4 v14, s[32:35], s76 offen lds
    s_add_u32 m0, s63, 13312
    v_mfma_f32_16x16x32_bf16 a[88:91], v[228:231], v[180:183], a[88:91]
    buffer_load_dwordx4 v15, s[32:35], s76 offen lds
    v_mfma_f32_16x16x32_bf16 a[92:95], v[228:231], v[188:191], a[92:95]
    s_waitcnt lgkmcnt(2)
    s_add_u32 m0, s63, 14336
    s_add_u32 s76, s67, 0
    v_mfma_f32_16x16x32_bf16 a[96:99], v[228:231], v[236:239], a[96:99]
    buffer_load_dwordx4 v14, s[32:35], s76 offen lds
    s_add_u32 m0, s63, 15360
    v_mfma_f32_16x16x32_bf16 a[108:111], v[196:199], v[252:255], a[108:111]
    buffer_load_dwordx4 v15, s[32:35], s76 offen lds
    v_mfma_f32_16x16x32_bf16 a[120:123], v[204:207], v[252:255], a[120:123]
    s_waitcnt lgkmcnt(0)
    s_add_u32 m0, s63, 16384
    s_add_u32 s76, s68, 0
    v_mfma_f32_16x16x32_bf16 a[124:127], v[244:247], v[212:215], a[124:127]
    buffer_load_dwordx4 v14, s[32:35], s76 offen lds
    s_add_u32 m0, s63, 17408
    v_mfma_f32_16x16x32_bf16 a[128:131], v[244:247], v[220:223], a[128:131]
    buffer_load_dwordx4 v15, s[32:35], s76 offen lds
    v_mfma_f32_16x16x32_bf16 a[132:135], v[244:247], v[252:255], a[132:135]
    s_waitcnt lgkmcnt(0)
    buffer_load_dwordx4 v[224:227], v26, s[40:43], 0 offen offset:384
    buffer_load_dwordx4 v[228:231], v26, s[40:43], 0 offen offset:448
    buffer_load_dwordx4 v[232:235], v28, s[44:47], 0 offen offset:384
    buffer_load_dwordx4 v[236:239], v28, s[44:47], 0 offen offset:448
    buffer_load_dwordx4 v[240:243], v27, s[40:43], 0 offen offset:384
    buffer_load_dwordx4 v[244:247], v27, s[40:43], 0 offen offset:448
    buffer_load_dwordx4 v[248:251], v28, s[48:51], 0 offen offset:384
    buffer_load_dwordx4 v[252:255], v28, s[48:51], 0 offen offset:448
    v_mfma_f32_16x16x32_bf16 a[64:67], v[64:67], v[80:83], a[64:67]
    s_waitcnt vmcnt(44)
    ds_read_b128 v[160:163], v40 offset:18432
    v_mfma_f32_16x16x32_bf16 a[68:71], v[64:67], v[88:91], a[68:71]
    ds_read_b128 v[164:167], v41 offset:18432
    s_waitcnt vmcnt(42)
    v_mfma_f32_16x16x32_bf16 a[76:79], v[72:75], v[80:83], a[76:79]
    ds_read_b128 v[168:171], v40 offset:20480
    ds_read_b128 v[172:175], v41 offset:20480
    v_mfma_f32_16x16x32_bf16 a[80:83], v[72:75], v[88:91], a[80:83]
    s_waitcnt vmcnt(40)
    ds_read_b128 v[176:179], v40 offset:22528
    v_mfma_f32_16x16x32_bf16 a[100:103], v[96:99], v[112:115], a[100:103]
    ds_read_b128 v[180:183], v41 offset:22528
    s_waitcnt lgkmcnt(4)
    v_mfma_f32_16x16x32_bf16 a[104:107], v[96:99], v[120:123], a[104:107]
    s_add_u32 m0, s63, 18432
    s_add_u32 s76, s69, 0
    v_mfma_f32_16x16x32_bf16 a[112:115], v[104:107], v[112:115], a[112:115]
    buffer_load_dwordx4 v14, s[32:35], s76 offen lds
    s_add_u32 m0, s63, 19456
    v_mfma_f32_16x16x32_bf16 a[116:119], v[104:107], v[120:123], a[116:119]
    buffer_load_dwordx4 v15, s[32:35], s76 offen lds
    s_waitcnt vmcnt(40)
    v_mfma_f32_16x16x32_bf16 a[64:67], v[68:71], v[84:87], a[64:67]
    ds_read_b128 v[184:187], v40 offset:24576
    ds_read_b128 v[188:191], v41 offset:24576
    v_mfma_f32_16x16x32_bf16 a[68:71], v[68:71], v[92:95], a[68:71]
    s_waitcnt vmcnt(38)
    ds_read_b128 v[192:195], v40 offset:26624
    v_mfma_f32_16x16x32_bf16 a[76:79], v[76:79], v[84:87], a[76:79]
    ds_read_b128 v[196:199], v41 offset:26624
    s_waitcnt lgkmcnt(4)
    v_mfma_f32_16x16x32_bf16 a[80:83], v[76:79], v[92:95], a[80:83]
    s_add_u32 m0, s63, 20480
    s_add_u32 s76, s64, 128
    v_mfma_f32_16x16x32_bf16 a[100:103], v[100:103], v[116:119], a[100:103]
    buffer_load_dwordx4 v10, s[36:39], s76 offen lds
    s_add_u32 m0, s63, 21504
    v_mfma_f32_16x16x32_bf16 a[104:107], v[100:103], v[124:127], a[104:107]
    buffer_load_dwordx4 v11, s[36:39], s76 offen lds
    s_add_u32 m0, s63, 22528
    v_mfma_f32_16x16x32_bf16 a[112:115], v[108:111], v[116:119], a[112:115]
    buffer_load_dwordx4 v12, s[36:39], s76 offen lds
    s_add_u32 m0, s63, 23552
    v_mfma_f32_16x16x32_bf16 a[116:119], v[108:111], v[124:127], a[116:119]
    buffer_load_dwordx4 v13, s[36:39], s76 offen lds
    s_waitcnt vmcnt(30)
    v_mfma_f32_16x16x32_bf16 a[72:75], v[64:67], v[136:139], a[72:75]
    s_waitcnt vmcnt(40)
    ds_read_b128 v[200:203], v40 offset:28672
    v_mfma_f32_16x16x32_bf16 a[84:87], v[72:75], v[136:139], a[84:87]
    ds_read_b128 v[204:207], v41 offset:28672
    s_waitcnt vmcnt(38)
    v_mfma_f32_16x16x32_bf16 a[88:91], v[128:131], v[80:83], a[88:91]
    ds_read_b128 v[208:211], v40 offset:0
    ds_read_b128 v[212:215], v41 offset:0
    v_mfma_f32_16x16x32_bf16 a[92:95], v[128:131], v[88:91], a[92:95]
    s_waitcnt lgkmcnt(4)
    s_add_u32 m0, s63, 24576
    s_add_u32 s76, s65, 128
    v_mfma_f32_16x16x32_bf16 a[96:99], v[128:131], v[136:139], a[96:99]
    buffer_load_dwordx4 v10, s[36:39], s76 offen lds
    s_add_u32 m0, s63, 25600
    v_mfma_f32_16x16x32_bf16 a[108:111], v[96:99], v[152:155], a[108:111]
    buffer_load_dwordx4 v11, s[36:39], s76 offen lds
    s_add_u32 m0, s63, 26624
    v_mfma_f32_16x16x32_bf16 a[120:123], v[104:107], v[152:155], a[120:123]
    buffer_load_dwordx4 v12, s[36:39], s76 offen lds
    s_add_u32 m0, s63, 27648
    v_mfma_f32_16x16x32_bf16 a[124:127], v[144:147], v[112:115], a[124:127]
    buffer_load_dwordx4 v13, s[36:39], s76 offen lds
    v_mfma_f32_16x16x32_bf16 a[128:131], v[144:147], v[120:123], a[128:131]
    s_waitcnt vmcnt(32)
    v_mfma_f32_16x16x32_bf16 a[132:135], v[144:147], v[152:155], a[132:135]
    ds_read_b128 v[216:219], v40 offset:2048
    ds_read_b128 v[220:223], v41 offset:2048
    v_mfma_f32_16x16x32_bf16 a[72:75], v[68:71], v[140:143], a[72:75]
    s_waitcnt lgkmcnt(4)
    s_add_u32 m0, s63, 28672
    s_add_u32 s76, s66, 128
    v_mfma_f32_16x16x32_bf16 a[84:87], v[76:79], v[140:143], a[84:87]
    buffer_load_dwordx4 v14, s[32:35], s76 offen lds
    s_add_u32 m0, s63, 29696
    v_mfma_f32_16x16x32_bf16 a[88:91], v[132:135], v[84:87], a[88:91]
    buffer_load_dwordx4 v15, s[32:35], s76 offen lds
    v_mfma_f32_16x16x32_bf16 a[92:95], v[132:135], v[92:95], a[92:95]
    s_waitcnt lgkmcnt(2)
    s_add_u32 m0, s63, 0
    s_add_u32 s76, s67, 128
    v_mfma_f32_16x16x32_bf16 a[96:99], v[132:135], v[140:143], a[96:99]
    buffer_load_dwordx4 v14, s[32:35], s76 offen lds
    s_add_u32 m0, s63, 1024
    v_mfma_f32_16x16x32_bf16 a[108:111], v[100:103], v[156:159], a[108:111]
    buffer_load_dwordx4 v15, s[32:35], s76 offen lds
    v_mfma_f32_16x16x32_bf16 a[120:123], v[108:111], v[156:159], a[120:123]
    s_waitcnt lgkmcnt(0)
    s_add_u32 m0, s63, 2048
    s_add_u32 s76, s68, 128
    v_mfma_f32_16x16x32_bf16 a[124:127], v[148:151], v[116:119], a[124:127]
    buffer_load_dwordx4 v14, s[32:35], s76 offen lds
    s_add_u32 m0, s63, 3072
    v_mfma_f32_16x16x32_bf16 a[128:131], v[148:151], v[124:127], a[128:131]
    buffer_load_dwordx4 v15, s[32:35], s76 offen lds
    v_mfma_f32_16x16x32_bf16 a[132:135], v[148:151], v[156:159], a[132:135]
    s_waitcnt lgkmcnt(0)
    v_mfma_f32_16x16x32_bf16 a[64:67], v[160:163], v[176:179], a[64:67]
    s_waitcnt vmcnt(34)
    ds_read_b128 v[64:67], v42 offset:4096
    v_mfma_f32_16x16x32_bf16 a[68:71], v[160:163], v[184:187], a[68:71]
    ds_read_b128 v[68:71], v43 offset:4096
    ds_read_b128 v[72:75], v42 offset:4608
    v_mfma_f32_16x16x32_bf16 a[76:79], v[168:171], v[176:179], a[76:79]
    ds_read_b128 v[76:79], v43 offset:4608
    s_waitcnt vmcnt(30)
    v_mfma_f32_16x16x32_bf16 a[80:83], v[168:171], v[184:187], a[80:83]
    ds_read_b128 v[80:83], v42 offset:8192
    ds_read_b128 v[84:87], v43 offset:8192
    v_mfma_f32_16x16x32_bf16 a[100:103], v[192:195], v[208:211], a[100:103]
    ds_read_b128 v[88:91], v42 offset:8704
    ds_read_b128 v[92:95], v43 offset:8704
    v_mfma_f32_16x16x32_bf16 a[104:107], v[192:195], v[216:219], a[104:107]
    s_waitcnt vmcnt(28)
    ds_read_b128 v[96:99], v40 offset:12288
    v_mfma_f32_16x16x32_bf16 a[112:115], v[200:203], v[208:211], a[112:115]
    ds_read_b128 v[100:103], v41 offset:12288
    s_waitcnt lgkmcnt(6)
    v_mfma_f32_16x16x32_bf16 a[116:119], v[200:203], v[216:219], a[116:119]
    s_add_u32 m0, s63, 4096
    s_add_u32 s76, s69, 128
    v_mfma_f32_16x16x32_bf16 a[64:67], v[164:167], v[180:183], a[64:67]
    buffer_load_dwordx4 v14, s[32:35], s76 offen lds
    s_add_u32 m0, s63, 5120
    v_mfma_f32_16x16x32_bf16 a[68:71], v[164:167], v[188:191], a[68:71]
    buffer_load_dwordx4 v15, s[32:35], s76 offen lds
    v_mfma_f32_16x16x32_bf16 a[76:79], v[172:175], v[180:183], a[76:79]
    s_waitcnt vmcnt(28)
    ds_read_b128 v[104:107], v40 offset:14336
    v_mfma_f32_16x16x32_bf16 a[80:83], v[172:175], v[188:191], a[80:83]
    ds_read_b128 v[108:111], v41 offset:14336
    s_waitcnt lgkmcnt(4)
    v_mfma_f32_16x16x32_bf16 a[100:103], v[196:199], v[212:215], a[100:103]
    s_add_u32 m0, s63, 6144
    s_add_u32 s76, s64, 256
    v_mfma_f32_16x16x32_bf16 a[104:107], v[196:199], v[220:223], a[104:107]
    buffer_load_dwordx4 v10, s[36:39], s76 offen lds
    s_add_u32 m0, s63, 7168
    v_mfma_f32_16x16x32_bf16 a[112:115], v[204:207], v[212:215], a[112:115]
    buffer_load_dwordx4 v11, s[36:39], s76 offen lds
    s_add_u32 m0, s63, 8192
    v_mfma_f32_16x16x32_bf16 a[116:119], v[204:207], v[220:223], a[116:119]
    buffer_load_dwordx4 v12, s[36:39], s76 offen lds
    s_add_u32 m0, s63, 9216
    s_waitcnt vmcnt(21)
    v_mfma_f32_16x16x32_bf16 a[72:75], v[160:163], v[232:235], a[72:75]
    buffer_load_dwordx4 v13, s[36:39], s76 offen lds
    v_mfma_f32_16x16x32_bf16 a[84:87], v[168:171], v[232:235], a[84:87]
    s_waitcnt vmcnt(30)
    ds_read_b128 v[112:115], v40 offset:16384
    v_mfma_f32_16x16x32_bf16 a[88:91], v[224:227], v[176:179], a[88:91]
    ds_read_b128 v[116:119], v41 offset:16384
    s_waitcnt lgkmcnt(4)
    v_mfma_f32_16x16x32_bf16 a[92:95], v[224:227], v[184:187], a[92:95]
    s_add_u32 m0, s63, 10240
    s_add_u32 s76, s65, 256
    v_mfma_f32_16x16x32_bf16 a[96:99], v[224:227], v[232:235], a[96:99]
    buffer_load_dwordx4 v10, s[36:39], s76 offen lds
    s_add_u32 m0, s63, 11264
    v_mfma_f32_16x16x32_bf16 a[108:111], v[192:195], v[248:251], a[108:111]
    buffer_load_dwordx4 v11, s[36:39], s76 offen lds
    s_add_u32 m0, s63, 12288
    v_mfma_f32_16x16x32_bf16 a[120:123], v[200:203], v[248:251], a[120:123]
    buffer_load_dwordx4 v12, s[36:39], s76 offen lds
    s_add_u32 m0, s63, 13312
    v_mfma_f32_16x16x32_bf16 a[124:127], v[240:243], v[208:211], a[124:127]
    buffer_load_dwordx4 v13, s[36:39], s76 offen lds
    v_mfma_f32_16x16x32_bf16 a[128:131], v[240:243], v[216:219], a[128:131]
    s_waitcnt vmcnt(24)
    ds_read_b128 v[120:123], v40 offset:18432
    v_mfma_f32_16x16x32_bf16 a[132:135], v[240:243], v[248:251], a[132:135]
    ds_read_b128 v[124:127], v41 offset:18432
    s_waitcnt lgkmcnt(4)
    v_mfma_f32_16x16x32_bf16 a[72:75], v[164:167], v[236:239], a[72:75]
    s_add_u32 m0, s63, 14336
    s_add_u32 s76, s66, 256
    v_mfma_f32_16x16x32_bf16 a[84:87], v[172:175], v[236:239], a[84:87]
    buffer_load_dwordx4 v14, s[32:35], s76 offen lds
    s_add_u32 m0, s63, 15360
    v_mfma_f32_16x16x32_bf16 a[88:91], v[228:231], v[180:183], a[88:91]
    buffer_load_dwordx4 v15, s[32:35], s76 offen lds
    v_mfma_f32_16x16x32_bf16 a[92:95], v[228:231], v[188:191], a[92:95]
    s_waitcnt lgkmcnt(2)
    s_add_u32 m0, s63, 16384
    s_add_u32 s76, s67, 256
    v_mfma_f32_16x16x32_bf16 a[96:99], v[228:231], v[236:239], a[96:99]
    buffer_load_dwordx4 v14, s[32:35], s76 offen lds
    s_add_u32 m0, s63, 17408
    v_mfma_f32_16x16x32_bf16 a[108:111], v[196:199], v[252:255], a[108:111]
    buffer_load_dwordx4 v15, s[32:35], s76 offen lds
    v_mfma_f32_16x16x32_bf16 a[120:123], v[204:207], v[252:255], a[120:123]
    s_waitcnt lgkmcnt(0)
    s_add_u32 m0, s63, 18432
    s_add_u32 s76, s68, 256
    v_mfma_f32_16x16x32_bf16 a[124:127], v[244:247], v[212:215], a[124:127]
    buffer_load_dwordx4 v14, s[32:35], s76 offen lds
    s_add_u32 m0, s63, 19456
    v_mfma_f32_16x16x32_bf16 a[128:131], v[244:247], v[220:223], a[128:131]
    buffer_load_dwordx4 v15, s[32:35], s76 offen lds
    v_mfma_f32_16x16x32_bf16 a[132:135], v[244:247], v[252:255], a[132:135]
    s_waitcnt lgkmcnt(0)
    v_mfma_f32_16x16x32_bf16 a[0:3], v[64:67], v[96:99], a[0:3]
    s_waitcnt vmcnt(26)
    ds_read_b128 v[160:163], v42 offset:20480
    v_accvgpr_read_b32 v128, a64
    v_accvgpr_read_b32 v129, a65
    ds_read_b128 v[164:167], v43 offset:20480
    v_mfma_f32_16x16x32_bf16 a[4:7], v[64:67], v[104:107], a[4:7]
    v_accvgpr_read_b32 v130, a66
    v_accvgpr_read_b32 v131, a67
    ds_read_b128 v[168:171], v42 offset:20992
    v_accvgpr_read_b32 v132, a100
    v_accvgpr_read_b32 v133, a101
    v_mfma_f32_16x16x32_bf16 a[8:11], v[64:67], v[112:115], a[8:11]
    ds_read_b128 v[172:175], v43 offset:20992
    v_accvgpr_read_b32 v134, a102
    v_accvgpr_read_b32 v135, a103
    s_waitcnt vmcnt(22)
    v_cndmask_b32 v132, v132, v39, s[58:59]
    v_mfma_f32_16x16x32_bf16 a[12:15], v[64:67], v[120:123], a[12:15]
    ds_read_b128 v[176:179], v42 offset:24576
    ds_read_b128 v[180:183], v43 offset:24576
    v_add_f32 v136, v128, v132
    v_sub_f32 v132, v128, v132
    v_mfma_f32_16x16x32_bf16 a[16:19], v[72:75], v[96:99], a[16:19]
    ds_read_b128 v[184:187], v42 offset:25088
    v_add_f32 v137, v129, v133
    v_sub_f32 v133, v129, v133
    ds_read_b128 v[188:191], v43 offset:25088
    v_add_f32 v138, v130, v134
    v_sub_f32 v134, v130, v134
    v_mfma_f32_16x16x32_bf16 a[20:23], v[72:75], v[104:107], a[20:23]
    s_waitcnt vmcnt(20)
    v_add_f32 v139, v131, v135
    v_sub_f32 v135, v131, v135
    ds_read_b128 v[192:195], v40 offset:28672
    v_mfma_f32_16x16x32_bf16 a[24:27], v[72:75], v[112:115], a[24:27]
    ds_write_b128 v49, v[136:139] offset:0
    ds_write_b128 v49, v[132:135] offset:4752
    ds_read_b128 v[196:199], v41 offset:28672
    s_waitcnt lgkmcnt(8)
    v_mfma_f32_16x16x32_bf16 a[28:31], v[72:75], v[120:123], a[28:31]
    v_accvgpr_read_b32 v140, a68
    v_accvgpr_read_b32 v141, a69
    s_add_u32 m0, s63, 20480
    s_add_u32 s76, s69, 256
    v_accvgpr_read_b32 v142, a70
    v_accvgpr_read_b32 v143, a71
    v_mfma_f32_16x16x32_bf16 a[32:35], v[80:83], v[96:99], a[32:35]
    buffer_load_dwordx4 v14, s[32:35], s76 offen lds
    s_add_u32 m0, s63, 21504
    v_accvgpr_read_b32 v144, a104
    v_accvgpr_read_b32 v145, a105
    v_mfma_f32_16x16x32_bf16 a[36:39], v[80:83], v[104:107], a[36:39]
    buffer_load_dwordx4 v15, s[32:35], s76 offen lds
    v_accvgpr_read_b32 v146, a106
    v_accvgpr_read_b32 v147, a107
    s_waitcnt vmcnt(20)
    v_mfma_f32_16x16x32_bf16 a[40:43], v[80:83], v[112:115], a[40:43]
    v_cndmask_b32 v144, v144, v39, s[58:59]
    ds_read_b128 v[200:203], v40 offset:0
    ds_read_b128 v[204:207], v41 offset:0
    v_add_f32 v148, v140, v144
    v_sub_f32 v144, v140, v144
    v_mfma_f32_16x16x32_bf16 a[44:47], v[80:83], v[120:123], a[44:47]
    s_waitcnt lgkmcnt(6)
    v_add_f32 v149, v141, v145
    v_sub_f32 v145, v141, v145
    s_add_u32 m0, s63, 22528
    s_add_u32 s76, s64, 384
    v_mfma_f32_16x16x32_bf16 a[48:51], v[88:91], v[96:99], a[48:51]
    v_add_f32 v150, v142, v146
    v_sub_f32 v146, v142, v146
    buffer_load_dwordx4 v10, s[36:39], s76 offen lds
    s_add_u32 m0, s63, 23552
    v_mfma_f32_16x16x32_bf16 a[52:55], v[88:91], v[104:107], a[52:55]
    v_add_f32 v151, v143, v147
    v_sub_f32 v147, v143, v147
    buffer_load_dwordx4 v11, s[36:39], s76 offen lds
    s_add_u32 m0, s63, 24576
    ds_write_b128 v49, v[148:151] offset:2304
    ds_write_b128 v49, v[144:147] offset:7056
    v_mfma_f32_16x16x32_bf16 a[56:59], v[88:91], v[112:115], a[56:59]
    buffer_load_dwordx4 v12, s[36:39], s76 offen lds
    s_add_u32 m0, s63, 25600
    v_accvgpr_read_b32 v224, a72
    v_accvgpr_read_b32 v225, a73
    v_mfma_f32_16x16x32_bf16 a[60:63], v[88:91], v[120:123], a[60:63]
    buffer_load_dwordx4 v13, s[36:39], s76 offen lds
    s_waitcnt vmcnt(22)
    v_accvgpr_read_b32 v226, a74
    v_accvgpr_read_b32 v227, a75
    v_mfma_f32_16x16x32_bf16 a[0:3], v[68:71], v[100:103], a[0:3]
    ds_read_b128 v[208:211], v40 offset:2048
    v_accvgpr_read_b32 v228, a108
    v_accvgpr_read_b32 v229, a109
    ds_read_b128 v[212:215], v41 offset:2048
    v_accvgpr_read_b32 v230, a110
    v_accvgpr_read_b32 v231, a111
    v_mfma_f32_16x16x32_bf16 a[4:7], v[68:71], v[108:111], a[4:7]
    s_waitcnt lgkmcnt(6)
    v_cndmask_b32 v228, v228, v39, s[58:59]
    s_add_u32 m0, s63, 26624
    s_add_u32 s76, s65, 384
    v_mfma_f32_16x16x32_bf16 a[8:11], v[68:71], v[116:119], a[8:11]
    v_add_f32 v232, v224, v228
    v_sub_f32 v228, v224, v228
    buffer_load_dwordx4 v10, s[36:39], s76 offen lds
    s_add_u32 m0, s63, 27648
    s_nop 0
    buffer_load_dwordx4 v11, s[36:39], s76 offen lds
    s_add_u32 m0, s63, 28672
    v_mfma_f32_16x16x32_bf16 a[12:15], v[68:71], v[124:127], a[12:15]
    v_add_f32 v233, v225, v229
    v_sub_f32 v229, v225, v229
    buffer_load_dwordx4 v12, s[36:39], s76 offen lds
    s_add_u32 m0, s63, 29696
    v_mfma_f32_16x16x32_bf16 a[16:19], v[76:79], v[100:103], a[16:19]
    v_add_f32 v234, v226, v230
    v_sub_f32 v230, v226, v230
    buffer_load_dwordx4 v13, s[36:39], s76 offen lds
    v_add_f32 v235, v227, v231
    v_sub_f32 v231, v227, v231
    v_mfma_f32_16x16x32_bf16 a[20:23], v[76:79], v[108:111], a[20:23]
    s_waitcnt vmcnt(24)
    s_mov_b64 exec, s[56:57]
    ds_write_b128 v49, v[232:235] offset:4608
    ds_write_b128 v49, v[228:231] offset:9360
    s_mov_b64 exec, -1
    v_mfma_f32_16x16x32_bf16 a[24:27], v[76:79], v[116:119], a[24:27]
    ds_read_b128 v[216:219], v40 offset:4096
    v_accvgpr_read_b32 v236, a76
    v_accvgpr_read_b32 v237, a77
    v_mfma_f32_16x16x32_bf16 a[28:31], v[76:79], v[124:127], a[28:31]
    ds_read_b128 v[220:223], v41 offset:4096
    s_waitcnt lgkmcnt(8)
    v_accvgpr_read_b32 v238, a78
    v_accvgpr_read_b32 v239, a79
    s_add_u32 m0, s63, 0
    s_add_u32 s76, s66, 384
    v_mfma_f32_16x16x32_bf16 a[32:35], v[84:87], v[100:103], a[32:35]
    v_accvgpr_read_b32 v240, a112
    v_accvgpr_read_b32 v241, a113
    buffer_load_dwordx4 v14, s[32:35], s76 offen lds
    s_add_u32 m0, s63, 1024
    v_mfma_f32_16x16x32_bf16 a[36:39], v[84:87], v[108:111], a[36:39]
    v_accvgpr_read_b32 v242, a114
    v_accvgpr_read_b32 v243, a115
    buffer_load_dwordx4 v15, s[32:35], s76 offen lds
    v_add_f32 v244, v236, v240
    v_sub_f32 v240, v236, v240
    v_mfma_f32_16x16x32_bf16 a[40:43], v[84:87], v[116:119], a[40:43]
    s_waitcnt lgkmcnt(4)
    v_add_f32 v245, v237, v241
    v_sub_f32 v241, v237, v241
    s_add_u32 m0, s63, 2048
    s_add_u32 s76, s67, 384
    v_mfma_f32_16x16x32_bf16 a[44:47], v[84:87], v[124:127], a[44:47]
    buffer_load_dwordx4 v14, s[32:35], s76 offen lds
    s_add_u32 m0, s63, 3072
    v_add_f32 v246, v238, v242
    v_sub_f32 v242, v238, v242
    v_mfma_f32_16x16x32_bf16 a[48:51], v[92:95], v[100:103], a[48:51]
    buffer_load_dwordx4 v15, s[32:35], s76 offen lds
    v_add_f32 v247, v239, v243
    v_sub_f32 v243, v239, v243
    s_waitcnt lgkmcnt(0)
    v_mfma_f32_16x16x32_bf16 a[52:55], v[92:95], v[108:111], a[52:55]
    ds_write_b128 v49, v[244:247] offset:64
    ds_write_b128 v49, v[240:243] offset:4816
    s_add_u32 m0, s63, 4096
    s_add_u32 s76, s68, 384
    v_accvgpr_read_b32 v128, a80
    v_accvgpr_read_b32 v129, a81
    v_mfma_f32_16x16x32_bf16 a[56:59], v[92:95], v[116:119], a[56:59]
    buffer_load_dwordx4 v14, s[32:35], s76 offen lds
    s_add_u32 m0, s63, 5120
    v_accvgpr_read_b32 v130, a82
    v_accvgpr_read_b32 v131, a83
    v_mfma_f32_16x16x32_bf16 a[60:63], v[92:95], v[124:127], a[60:63]
    buffer_load_dwordx4 v15, s[32:35], s76 offen lds
    v_accvgpr_read_b32 v132, a116
    v_accvgpr_read_b32 v133, a117
    s_waitcnt lgkmcnt(0)
    v_mfma_f32_16x16x32_bf16 a[0:3], v[160:163], v[192:195], a[0:3]
    s_waitcnt vmcnt(26)
    ds_read_b128 v[64:67], v42 offset:6144
    v_accvgpr_read_b32 v134, a118
    v_accvgpr_read_b32 v135, a119
    ds_read_b128 v[68:71], v43 offset:6144
    v_mfma_f32_16x16x32_bf16 a[4:7], v[160:163], v[200:203], a[4:7]
    v_add_f32 v136, v128, v132
    v_sub_f32 v132, v128, v132
    ds_read_b128 v[72:75], v42 offset:6656
    v_add_f32 v137, v129, v133
    v_sub_f32 v133, v129, v133
    v_mfma_f32_16x16x32_bf16 a[8:11], v[160:163], v[208:211], a[8:11]
    ds_read_b128 v[76:79], v43 offset:6656
    v_add_f32 v138, v130, v134
    v_sub_f32 v134, v130, v134
    s_waitcnt vmcnt(22)
    v_add_f32 v139, v131, v135
    v_sub_f32 v135, v131, v135
    v_mfma_f32_16x16x32_bf16 a[12:15], v[160:163], v[216:219], a[12:15]
    ds_read_b128 v[80:83], v42 offset:10240
    ds_read_b128 v[84:87], v43 offset:10240
    ds_write_b128 v49, v[136:139] offset:2368
    ds_write_b128 v49, v[132:135] offset:7120
    v_mfma_f32_16x16x32_bf16 a[16:19], v[168:171], v[192:195], a[16:19]
    ds_read_b128 v[88:91], v42 offset:10752
    v_accvgpr_read_b32 v140, a84
    v_accvgpr_read_b32 v141, a85
    ds_read_b128 v[92:95], v43 offset:10752
    v_accvgpr_read_b32 v142, a86
    v_accvgpr_read_b32 v143, a87
    v_mfma_f32_16x16x32_bf16 a[20:23], v[168:171], v[200:203], a[20:23]
    s_waitcnt vmcnt(20)
    v_accvgpr_read_b32 v144, a120
    v_accvgpr_read_b32 v145, a121
    ds_read_b128 v[96:99], v40 offset:14336
    v_mfma_f32_16x16x32_bf16 a[24:27], v[168:171], v[208:211], a[24:27]
    v_accvgpr_read_b32 v146, a122
    v_accvgpr_read_b32 v147, a123
    ds_read_b128 v[100:103], v41 offset:14336
    s_waitcnt lgkmcnt(8)
    v_add_f32 v148, v140, v144
    v_sub_f32 v144, v140, v144
    v_mfma_f32_16x16x32_bf16 a[28:31], v[168:171], v[216:219], a[28:31]
    s_add_u32 m0, s63, 6144
    s_add_u32 s76, s69, 384
    v_add_f32 v149, v141, v145
    v_sub_f32 v145, v141, v145
    v_mfma_f32_16x16x32_bf16 a[32:35], v[176:179], v[192:195], a[32:35]
    buffer_load_dwordx4 v14, s[32:35], s76 offen lds
    s_add_u32 m0, s63, 7168
    v_add_f32 v150, v142, v146
    v_sub_f32 v146, v142, v146
    buffer_load_dwordx4 v15, s[32:35], s76 offen lds
    v_mfma_f32_16x16x32_bf16 a[36:39], v[176:179], v[200:203], a[36:39]
    v_add_f32 v151, v143, v147
    v_sub_f32 v147, v143, v147
    s_waitcnt vmcnt(20)
    s_mov_b64 exec, s[56:57]
    ds_write_b128 v49, v[148:151] offset:4672
    ds_write_b128 v49, v[144:147] offset:9424
    s_mov_b64 exec, -1
    v_mfma_f32_16x16x32_bf16 a[40:43], v[176:179], v[208:211], a[40:43]
    ds_read_b128 v[104:107], v40 offset:16384
    ds_read_b128 v[108:111], v41 offset:16384
    v_accvgpr_read_b32 v224, a88
    v_accvgpr_read_b32 v225, a89
    v_mfma_f32_16x16x32_bf16 a[44:47], v[176:179], v[216:219], a[44:47]
    s_waitcnt lgkmcnt(6)
    v_accvgpr_read_b32 v226, a90
    v_accvgpr_read_b32 v227, a91
    s_add_u32 m0, s63, 8192
    s_add_u32 s76, s64, 512
    v_mfma_f32_16x16x32_bf16 a[48:51], v[184:187], v[192:195], a[48:51]
    v_accvgpr_read_b32 v228, a124
    v_accvgpr_read_b32 v229, a125
    buffer_load_dwordx4 v10, s[36:39], s76 offen lds
    s_add_u32 m0, s63, 9216
    v_mfma_f32_16x16x32_bf16 a[52:55], v[184:187], v[200:203], a[52:55]
    v_accvgpr_read_b32 v230, a126
    v_accvgpr_read_b32 v231, a127
    buffer_load_dwordx4 v11, s[36:39], s76 offen lds
    s_add_u32 m0, s63, 10240
    v_add_f32 v232, v224, v228
    v_sub_f32 v228, v224, v228
    v_mfma_f32_16x16x32_bf16 a[56:59], v[184:187], v[208:211], a[56:59]
    buffer_load_dwordx4 v12, s[36:39], s76 offen lds
    s_add_u32 m0, s63, 11264
    v_add_f32 v233, v225, v229
    v_sub_f32 v229, v225, v229
    v_mfma_f32_16x16x32_bf16 a[60:63], v[184:187], v[216:219], a[60:63]
    buffer_load_dwordx4 v13, s[36:39], s76 offen lds
    s_waitcnt vmcnt(22)
    v_add_f32 v234, v226, v230
    v_sub_f32 v230, v226, v230
    ds_read_b128 v[112:115], v40 offset:18432
    v_mfma_f32_16x16x32_bf16 a[0:3], v[164:167], v[196:199], a[0:3]
    v_add_f32 v235, v227, v231
    v_sub_f32 v231, v227, v231
    ds_read_b128 v[116:119], v41 offset:18432
    s_mov_b64 exec, 0xffff
    ds_write_b128 v49, v[232:235] offset:128
    ds_write_b128 v49, v[228:231] offset:4880
    s_mov_b64 exec, -1
    v_mfma_f32_16x16x32_bf16 a[4:7], v[164:167], v[204:207], a[4:7]
    s_waitcnt lgkmcnt(8)
    v_accvgpr_read_b32 v236, a92
    v_accvgpr_read_b32 v237, a93
    v_mfma_f32_16x16x32_bf16 a[8:11], v[164:167], v[212:215], a[8:11]
    s_add_u32 m0, s63, 12288
    s_add_u32 s76, s65, 512
    v_accvgpr_read_b32 v238, a94
    v_accvgpr_read_b32 v239, a95
    buffer_load_dwordx4 v10, s[36:39], s76 offen lds
    s_add_u32 m0, s63, 13312
    v_mfma_f32_16x16x32_bf16 a[12:15], v[164:167], v[220:223], a[12:15]
    buffer_load_dwordx4 v11, s[36:39], s76 offen lds
    s_add_u32 m0, s63, 14336
    v_accvgpr_read_b32 v240, a128
    v_accvgpr_read_b32 v241, a129
    v_mfma_f32_16x16x32_bf16 a[16:19], v[172:175], v[196:199], a[16:19]
    buffer_load_dwordx4 v12, s[36:39], s76 offen lds
    s_add_u32 m0, s63, 15360
    v_accvgpr_read_b32 v242, a130
    v_accvgpr_read_b32 v243, a131
    buffer_load_dwordx4 v13, s[36:39], s76 offen lds
    v_mfma_f32_16x16x32_bf16 a[20:23], v[172:175], v[204:207], a[20:23]
    v_add_f32 v244, v236, v240
    v_sub_f32 v240, v236, v240
    s_waitcnt vmcnt(24)
    v_add_f32 v245, v237, v241
    v_sub_f32 v241, v237, v241
    v_mfma_f32_16x16x32_bf16 a[24:27], v[172:175], v[212:215], a[24:27]
    ds_read_b128 v[120:123], v40 offset:20480
    v_add_f32 v246, v238, v242
    v_sub_f32 v242, v238, v242
    ds_read_b128 v[124:127], v41 offset:20480
    s_waitcnt lgkmcnt(6)
    v_mfma_f32_16x16x32_bf16 a[28:31], v[172:175], v[220:223], a[28:31]
    v_add_f32 v247, v239, v243
    v_sub_f32 v243, v239, v243
    s_add_u32 m0, s63, 16384
    s_add_u32 s76, s66, 512
    s_mov_b64 exec, 0xffff
    ds_write_b128 v49, v[244:247] offset:2432
    ds_write_b128 v49, v[240:243] offset:7184
    s_mov_b64 exec, -1
    v_mfma_f32_16x16x32_bf16 a[32:35], v[180:183], v[196:199], a[32:35]
    buffer_load_dwordx4 v14, s[32:35], s76 offen lds
    s_add_u32 m0, s63, 17408
    v_mfma_f32_16x16x32_bf16 a[36:39], v[180:183], v[204:207], a[36:39]
    v_accvgpr_read_b32 v128, a96
    v_accvgpr_read_b32 v129, a97
    buffer_load_dwordx4 v15, s[32:35], s76 offen lds
    v_accvgpr_read_b32 v130, a98
    v_accvgpr_read_b32 v131, a99
    v_mfma_f32_16x16x32_bf16 a[40:43], v[180:183], v[212:215], a[40:43]
    s_waitcnt lgkmcnt(6)
    v_accvgpr_read_b32 v132, a132
    v_accvgpr_read_b32 v133, a133
    s_add_u32 m0, s63, 18432
    s_add_u32 s76, s67, 512
    v_mfma_f32_16x16x32_bf16 a[44:47], v[180:183], v[220:223], a[44:47]
    buffer_load_dwordx4 v14, s[32:35], s76 offen lds
    s_add_u32 m0, s63, 19456
    v_accvgpr_read_b32 v134, a134
    v_accvgpr_read_b32 v135, a135
    buffer_load_dwordx4 v15, s[32:35], s76 offen lds
    v_mfma_f32_16x16x32_bf16 a[48:51], v[188:191], v[196:199], a[48:51]
    v_add_f32 v136, v128, v132
    v_sub_f32 v132, v128, v132
    s_waitcnt lgkmcnt(2)
    v_add_f32 v137, v129, v133
    v_sub_f32 v133, v129, v133
    v_mfma_f32_16x16x32_bf16 a[52:55], v[188:191], v[204:207], a[52:55]
    s_add_u32 m0, s63, 20480
    s_add_u32 s76, s68, 512
    v_add_f32 v138, v130, v134
    v_sub_f32 v134, v130, v134
    buffer_load_dwordx4 v14, s[32:35], s76 offen lds
    s_add_u32 m0, s63, 21504
    v_mfma_f32_16x16x32_bf16 a[56:59], v[188:191], v[212:215], a[56:59]
    v_add_f32 v139, v131, v135
    v_sub_f32 v135, v131, v135
    buffer_load_dwordx4 v15, s[32:35], s76 offen lds
    s_mov_b64 exec, 1
    ds_write_b128 v49, v[136:139] offset:4736
    ds_write_b128 v49, v[132:135] offset:9488
    s_mov_b64 exec, -1
    v_mfma_f32_16x16x32_bf16 a[60:63], v[188:191], v[220:223], a[60:63]
    s_waitcnt lgkmcnt(0)
    s_barrier
    v_mfma_f32_16x16x32_bf16 a[0:3], v[64:67], v[96:99], a[0:3]
    s_waitcnt vmcnt(26)
    ds_read_b128 v[160:163], v42 offset:22528
    ds_read_b128 v[164:167], v43 offset:22528
    v_mfma_f32_16x16x32_bf16 a[4:7], v[64:67], v[104:107], a[4:7]
    ds_read_b128 v[168:171], v42 offset:23040
    ds_read_b128 v[172:175], v43 offset:23040
    v_mfma_f32_16x16x32_bf16 a[8:11], v[64:67], v[112:115], a[8:11]
    s_waitcnt vmcnt(22)
    ds_read_b128 v[128:131], v44 offset:0
    ds_read_b128 v[132:135], v44 offset:16
    v_mfma_f32_16x16x32_bf16 a[12:15], v[64:67], v[120:123], a[12:15]
    ds_read_b128 v[176:179], v42 offset:26624
    ds_read_b128 v[180:183], v43 offset:26624
    v_mfma_f32_16x16x32_bf16 a[16:19], v[72:75], v[96:99], a[16:19]
    ds_read_b128 v[184:187], v42 offset:27136
    ds_read_b128 v[188:191], v43 offset:27136
    s_waitcnt vmcnt(20)
    v_mfma_f32_16x16x32_bf16 a[20:23], v[72:75], v[104:107], a[20:23]
    ds_read_b128 v[192:195], v40 offset:0
    ds_read_b128 v[136:139], v44 offset:9504
    ds_read_b128 v[140:143], v44 offset:9520
    v_mfma_f32_16x16x32_bf16 a[24:27], v[72:75], v[112:115], a[24:27]
    ds_read_b128 v[196:199], v41 offset:0
    v_mfma_f32_16x16x32_bf16 a[28:31], v[72:75], v[120:123], a[28:31]
    s_waitcnt lgkmcnt(10)
    s_add_u32 m0, s63, 22528
    s_add_u32 s76, s69, 512
    v_mfma_f32_16x16x32_bf16 a[32:35], v[80:83], v[96:99], a[32:35]
    buffer_load_dwordx4 v14, s[32:35], s76 offen lds
    s_add_u32 m0, s63, 23552
    v_mfma_f32_16x16x32_bf16 a[36:39], v[80:83], v[104:107], a[36:39]
    buffer_load_dwordx4 v15, s[32:35], s76 offen lds
    s_waitcnt vmcnt(20)
    ds_read_b128 v[144:147], v44 offset:19008
    ds_read_b128 v[148:151], v44 offset:19024
    v_mfma_f32_16x16x32_bf16 a[40:43], v[80:83], v[112:115], a[40:43]
    ds_read_b128 v[200:203], v40 offset:2048
    v_mfma_f32_16x16x32_bf16 a[44:47], v[80:83], v[120:123], a[44:47]
    ds_read_b128 v[204:207], v41 offset:2048
    s_waitcnt lgkmcnt(8)
    v_mfma_f32_16x16x32_bf16 a[48:51], v[88:91], v[96:99], a[48:51]
    s_add_u32 m0, s63, 24576
    s_add_u32 s76, s64, 640
    buffer_load_dwordx4 v10, s[36:39], s76 offen lds
    s_add_u32 m0, s63, 25600
    v_mfma_f32_16x16x32_bf16 a[52:55], v[88:91], v[104:107], a[52:55]
    ds_read_b128 v[152:155], v44 offset:28512
    ds_read_b128 v[156:159], v44 offset:28528
    v_mfma_f32_16x16x32_bf16 a[56:59], v[88:91], v[112:115], a[56:59]
    buffer_load_dwordx4 v11, s[36:39], s76 offen lds
    s_add_u32 m0, s63, 26624
    v_mfma_f32_16x16x32_bf16 a[60:63], v[88:91], v[120:123], a[60:63]
    buffer_load_dwordx4 v12, s[36:39], s76 offen lds
    s_add_u32 m0, s63, 27648
    v_mfma_f32_16x16x32_bf16 a[0:3], v[68:71], v[100:103], a[0:3]
    buffer_load_dwordx4 v13, s[36:39], s76 offen lds
    s_waitcnt vmcnt(22)
    v_mfma_f32_16x16x32_bf16 a[4:7], v[68:71], v[108:111], a[4:7]
    ds_read_b128 v[208:211], v40 offset:4096
    ds_read_b128 v[212:215], v41 offset:4096
    ds_read_b128 v[224:227], v45 offset:0
    ds_read_b128 v[228:231], v45 offset:16
    v_mfma_f32_16x16x32_bf16 a[8:11], v[68:71], v[116:119], a[8:11]
    s_waitcnt vmcnt(20)
    v_mfma_f32_16x16x32_bf16 a[12:15], v[68:71], v[124:127], a[12:15]
    ds_read_b128 v[216:219], v40 offset:6144
    ds_read_b128 v[220:223], v41 offset:6144
    s_waitcnt lgkmcnt(8)
    v_mfma_f32_16x16x32_bf16 a[16:19], v[76:79], v[100:103], a[16:19]
    s_add_u32 m0, s63, 0
    s_add_u32 s76, s65, 640
    v_mfma_f32_16x16x32_bf16 a[20:23], v[76:79], v[108:111], a[20:23]
    buffer_load_dwordx4 v10, s[36:39], s76 offen lds
    s_add_u32 m0, s63, 1024
    v_mfma_f32_16x16x32_bf16 a[24:27], v[76:79], v[116:119], a[24:27]
    ds_read_b128 v[232:235], v45 offset:9504
    ds_read_b128 v[236:239], v45 offset:9520
    buffer_load_dwordx4 v11, s[36:39], s76 offen lds
    s_add_u32 m0, s63, 2048
    v_mfma_f32_16x16x32_bf16 a[28:31], v[76:79], v[124:127], a[28:31]
    buffer_load_dwordx4 v12, s[36:39], s76 offen lds
    s_add_u32 m0, s63, 3072
    v_mfma_f32_16x16x32_bf16 a[32:35], v[84:87], v[100:103], a[32:35]
    buffer_load_dwordx4 v13, s[36:39], s76 offen lds
    s_waitcnt lgkmcnt(6)
    v_mfma_f32_16x16x32_bf16 a[36:39], v[84:87], v[108:111], a[36:39]
    s_add_u32 m0, s63, 4096
    s_add_u32 s76, s66, 640
    v_mfma_f32_16x16x32_bf16 a[40:43], v[84:87], v[116:119], a[40:43]
    buffer_load_dwordx4 v14, s[32:35], s76 offen lds
    s_add_u32 m0, s63, 5120
    v_mfma_f32_16x16x32_bf16 a[44:47], v[84:87], v[124:127], a[44:47]
    ds_read_b128 v[240:243], v45 offset:19008
    ds_read_b128 v[244:247], v45 offset:19024
    buffer_load_dwordx4 v15, s[32:35], s76 offen lds
    v_mfma_f32_16x16x32_bf16 a[48:51], v[92:95], v[100:103], a[48:51]
    s_waitcnt lgkmcnt(4)
    s_add_u32 m0, s63, 6144
    s_add_u32 s76, s67, 640
    v_mfma_f32_16x16x32_bf16 a[52:55], v[92:95], v[108:111], a[52:55]
    buffer_load_dwordx4 v14, s[32:35], s76 offen lds
    s_add_u32 m0, s63, 7168
    v_mfma_f32_16x16x32_bf16 a[56:59], v[92:95], v[116:119], a[56:59]
    buffer_load_dwordx4 v15, s[32:35], s76 offen lds
    ds_read_b128 v[248:251], v45 offset:28512
    ds_read_b128 v[252:255], v45 offset:28528
    v_mfma_f32_16x16x32_bf16 a[60:63], v[92:95], v[124:127], a[60:63]
    s_waitcnt lgkmcnt(0)
    v_mfma_f32_16x16x32_bf16 a[0:3], v[160:163], v[192:195], a[0:3]
    s_waitcnt vmcnt(24)
    ds_read_b128 v[64:67], v42 offset:8192
    v_add_f32 v128, v128, v136
    v_add_f32 v144, v144, v152
    v_mfma_f32_16x16x32_bf16 a[4:7], v[160:163], v[200:203], a[4:7]
    ds_read_b128 v[68:71], v43 offset:8192
    ds_read_b128 v[72:75], v42 offset:8704
    v_add_f32 v129, v129, v137
    v_add_f32 v145, v145, v153
    v_mfma_f32_16x16x32_bf16 a[8:11], v[160:163], v[208:211], a[8:11]
    ds_read_b128 v[76:79], v43 offset:8704
    s_waitcnt vmcnt(20)
    v_add_f32 v130, v130, v138
    v_add_f32 v146, v146, v154
    v_mfma_f32_16x16x32_bf16 a[12:15], v[160:163], v[216:219], a[12:15]
    ds_read_b128 v[80:83], v42 offset:12288
    ds_read_b128 v[84:87], v43 offset:12288
    v_add_f32 v131, v131, v139
    v_add_f32 v147, v147, v155
    v_mfma_f32_16x16x32_bf16 a[16:19], v[168:171], v[192:195], a[16:19]
    ds_read_b128 v[88:91], v42 offset:12800
    ds_read_b128 v[92:95], v43 offset:12800
    v_mfma_f32_16x16x32_bf16 a[20:23], v[168:171], v[200:203], a[20:23]
    v_add_f32 v132, v132, v140
    v_add_f32 v148, v148, v156
    s_waitcnt vmcnt(18)
    ds_read_b128 v[96:99], v40 offset:16384
    v_mfma_f32_16x16x32_bf16 a[24:27], v[168:171], v[208:211], a[24:27]
    v_add_f32 v133, v133, v141
    v_add_f32 v149, v149, v157
    ds_read_b128 v[100:103], v41 offset:16384
    v_mfma_f32_16x16x32_bf16 a[28:31], v[168:171], v[216:219], a[28:31]
    s_waitcnt lgkmcnt(6)
    v_add_f32 v134, v134, v142
    v_add_f32 v150, v150, v158
    s_add_u32 m0, s63, 8192
    s_add_u32 s76, s68, 640
    v_mfma_f32_16x16x32_bf16 a[32:35], v[176:179], v[192:195], a[32:35]
    buffer_load_dwordx4 v14, s[32:35], s76 offen lds
    s_add_u32 m0, s63, 9216
    v_add_f32 v135, v135, v143
    v_add_f32 v151, v151, v159
    v_mfma_f32_16x16x32_bf16 a[36:39], v[176:179], v[200:203], a[36:39]
    buffer_load_dwordx4 v15, s[32:35], s76 offen lds
    s_add_u32 m0, s63, 10240
    s_add_u32 s76, s69, 640
    v_mfma_f32_16x16x32_bf16 a[40:43], v[176:179], v[208:211], a[40:43]
    buffer_load_dwordx4 v14, s[32:35], s76 offen lds
    s_add_u32 m0, s63, 11264
    v_add_f32 v128, v128, v144
    v_add_f32 v129, v129, v145
    v_mfma_f32_16x16x32_bf16 a[44:47], v[176:179], v[216:219], a[44:47]
    buffer_load_dwordx4 v15, s[32:35], s76 offen lds
    s_waitcnt vmcnt(20)
    v_mfma_f32_16x16x32_bf16 a[48:51], v[184:187], v[192:195], a[48:51]
    v_add_f32 v130, v130, v146
    v_add_f32 v131, v131, v147
    ds_read_b128 v[104:107], v40 offset:18432
    ds_read_b128 v[108:111], v41 offset:18432
    v_mfma_f32_16x16x32_bf16 a[52:55], v[184:187], v[200:203], a[52:55]
    v_add_f32 v132, v132, v148
    v_add_f32 v133, v133, v149
    s_waitcnt lgkmcnt(4)
    v_mfma_f32_16x16x32_bf16 a[56:59], v[184:187], v[208:211], a[56:59]
    s_add_u32 m0, s63, 12288
    s_add_u32 s76, s64, 768
    v_add_f32 v134, v134, v150
    v_add_f32 v135, v135, v151
    v_mfma_f32_16x16x32_bf16 a[60:63], v[184:187], v[216:219], a[60:63]
    buffer_load_dwordx4 v10, s[36:39], s76 offen lds
    s_add_u32 m0, s63, 13312
    s_nop 0
    buffer_load_dwordx4 v11, s[36:39], s76 offen lds
    s_add_u32 m0, s63, 14336
    v_mfma_f32_16x16x32_bf16 a[0:3], v[164:167], v[196:199], a[0:3]
    v_add_f32 v224, v224, v232
    v_add_f32 v240, v240, v248
    buffer_load_dwordx4 v12, s[36:39], s76 offen lds
    s_add_u32 m0, s63, 15360
    v_mfma_f32_16x16x32_bf16 a[4:7], v[164:167], v[204:207], a[4:7]
    buffer_load_dwordx4 v13, s[36:39], s76 offen lds
    v_add_f32 v225, v225, v233
    v_add_f32 v241, v241, v249
    v_mfma_f32_16x16x32_bf16 a[8:11], v[164:167], v[212:215], a[8:11]
    s_waitcnt vmcnt(22)
    ds_read_b128 v[112:115], v40 offset:20480
    v_add_f32 v226, v226, v234
    v_add_f32 v242, v242, v250
    v_mfma_f32_16x16x32_bf16 a[12:15], v[164:167], v[220:223], a[12:15]
    ds_read_b128 v[116:119], v41 offset:20480
    s_waitcnt vmcnt(20)
    v_add_f32 v227, v227, v235
    v_add_f32 v243, v243, v251
    v_mfma_f32_16x16x32_bf16 a[16:19], v[172:175], v[196:199], a[16:19]
    ds_read_b128 v[120:123], v40 offset:22528
    ds_read_b128 v[124:127], v41 offset:22528
    v_mfma_f32_16x16x32_bf16 a[20:23], v[172:175], v[204:207], a[20:23]
    v_add_f32 v228, v228, v236
    v_add_f32 v244, v244, v252
    s_waitcnt lgkmcnt(4)
    s_add_u32 m0, s63, 16384
    s_add_u32 s76, s65, 768
    v_mfma_f32_16x16x32_bf16 a[24:27], v[172:175], v[212:215], a[24:27]
    v_add_f32 v229, v229, v237
    v_add_f32 v245, v245, v253
    v_mfma_f32_16x16x32_bf16 a[28:31], v[172:175], v[220:223], a[28:31]
    buffer_load_dwordx4 v10, s[36:39], s76 offen lds
    s_add_u32 m0, s63, 17408
    s_nop 0
    buffer_load_dwordx4 v11, s[36:39], s76 offen lds
    s_add_u32 m0, s63, 18432
    v_mfma_f32_16x16x32_bf16 a[32:35], v[180:183], v[196:199], a[32:35]
    v_add_f32 v230, v230, v238
    v_add_f32 v246, v246, v254
    buffer_load_dwordx4 v12, s[36:39], s76 offen lds
    s_add_u32 m0, s63, 19456
    v_mfma_f32_16x16x32_bf16 a[36:39], v[180:183], v[204:207], a[36:39]
    buffer_load_dwordx4 v13, s[36:39], s76 offen lds
    v_add_f32 v231, v231, v239
    v_add_f32 v247, v247, v255
    v_mfma_f32_16x16x32_bf16 a[40:43], v[180:183], v[212:215], a[40:43]
    s_waitcnt lgkmcnt(2)
    s_add_u32 m0, s63, 20480
    s_add_u32 s76, s66, 768
    v_add_f32 v224, v224, v240
    v_add_f32 v225, v225, v241
    v_mfma_f32_16x16x32_bf16 a[44:47], v[180:183], v[220:223], a[44:47]
    buffer_load_dwordx4 v14, s[32:35], s76 offen lds
    s_add_u32 m0, s63, 21504
    v_mfma_f32_16x16x32_bf16 a[48:51], v[188:191], v[196:199], a[48:51]
    buffer_load_dwordx4 v15, s[32:35], s76 offen lds
    v_add_f32 v226, v226, v242
    v_add_f32 v227, v227, v243
    s_waitcnt lgkmcnt(0)
    v_mfma_f32_16x16x32_bf16 a[52:55], v[188:191], v[204:207], a[52:55]
    s_add_u32 m0, s63, 22528
    s_add_u32 s76, s67, 768
    v_add_f32 v228, v228, v244
    v_add_f32 v229, v229, v245
    v_mfma_f32_16x16x32_bf16 a[56:59], v[188:191], v[212:215], a[56:59]
    buffer_load_dwordx4 v14, s[32:35], s76 offen lds
    s_add_u32 m0, s63, 23552
    s_nop 0
    buffer_load_dwordx4 v15, s[32:35], s76 offen lds
    v_mfma_f32_16x16x32_bf16 a[60:63], v[188:191], v[220:223], a[60:63]
    v_add_f32 v230, v230, v246
    v_add_f32 v231, v231, v247
    s_waitcnt lgkmcnt(0)
    v_mfma_f32_16x16x32_bf16 a[0:3], v[64:67], v[96:99], a[0:3]
    s_waitcnt vmcnt(24)
    ds_read_b128 v[160:163], v42 offset:24576
    v_mfma_f32_16x16x32_bf16 a[4:7], v[64:67], v[104:107], a[4:7]
    ds_read_b128 v[164:167], v43 offset:24576
    v_mfma_f32_16x16x32_bf16 a[8:11], v[64:67], v[112:115], a[8:11]
    ds_read_b128 v[168:171], v42 offset:25088
    v_mfma_f32_16x16x32_bf16 a[12:15], v[64:67], v[120:123], a[12:15]
    ds_read_b128 v[172:175], v43 offset:25088
    v_mfma_f32_16x16x32_bf16 a[16:19], v[72:75], v[96:99], a[16:19]
    s_waitcnt vmcnt(20)
    v_mfma_f32_16x16x32_bf16 a[20:23], v[72:75], v[104:107], a[20:23]
    ds_read_b128 v[176:179], v42 offset:0
    v_mfma_f32_16x16x32_bf16 a[24:27], v[72:75], v[112:115], a[24:27]
    ds_read_b128 v[180:183], v43 offset:0
    v_mfma_f32_16x16x32_bf16 a[28:31], v[72:75], v[120:123], a[28:31]
    ds_read_b128 v[184:187], v42 offset:512
    v_mfma_f32_16x16x32_bf16 a[32:35], v[80:83], v[96:99], a[32:35]
    ds_read_b128 v[188:191], v43 offset:512
    s_waitcnt vmcnt(18)
    v_mfma_f32_16x16x32_bf16 a[36:39], v[80:83], v[104:107], a[36:39]
    ds_read_b128 v[192:195], v40 offset:4096
    v_mfma_f32_16x16x32_bf16 a[40:43], v[80:83], v[112:115], a[40:43]
    ds_read_b128 v[196:199], v41 offset:4096
    v_mfma_f32_16x16x32_bf16 a[44:47], v[80:83], v[120:123], a[44:47]
    s_waitcnt lgkmcnt(6)
    v_mfma_f32_16x16x32_bf16 a[48:51], v[88:91], v[96:99], a[48:51]
    buffer_load_dwordx4 v[136:139], v46, s[24:27], 0 offen
    v_mfma_f32_16x16x32_bf16 a[52:55], v[88:91], v[104:107], a[52:55]
    s_add_u32 m0, s63, 24576
    s_add_u32 s76, s68, 768
    v_mfma_f32_16x16x32_bf16 a[56:59], v[88:91], v[112:115], a[56:59]
    v_mfma_f32_16x16x32_bf16 a[60:63], v[88:91], v[120:123], a[60:63]
    buffer_load_dwordx4 v14, s[32:35], s76 offen lds
    s_add_u32 m0, s63, 25600
    v_mfma_f32_16x16x32_bf16 a[0:3], v[68:71], v[100:103], a[0:3]
    buffer_load_dwordx4 v15, s[32:35], s76 offen lds
    s_add_u32 m0, s63, 26624
    s_add_u32 s76, s69, 768
    v_mfma_f32_16x16x32_bf16 a[4:7], v[68:71], v[108:111], a[4:7]
    v_mfma_f32_16x16x32_bf16 a[8:11], v[68:71], v[116:119], a[8:11]
    v_mfma_f32_16x16x32_bf16 a[12:15], v[68:71], v[124:127], a[12:15]
    buffer_load_dwordx4 v14, s[32:35], s76 offen lds
    s_add_u32 m0, s63, 27648
    v_mfma_f32_16x16x32_bf16 a[16:19], v[76:79], v[100:103], a[16:19]
    v_mfma_f32_16x16x32_bf16 a[20:23], v[76:79], v[108:111], a[20:23]
    buffer_load_dwordx4 v15, s[32:35], s76 offen lds
    v_mfma_f32_16x16x32_bf16 a[24:27], v[76:79], v[116:119], a[24:27]
    s_waitcnt vmcnt(21)
    v_mfma_f32_16x16x32_bf16 a[28:31], v[76:79], v[124:127], a[28:31]
    ds_read_b128 v[200:203], v40 offset:6144
    v_mfma_f32_16x16x32_bf16 a[32:35], v[84:87], v[100:103], a[32:35]
    ds_read_b128 v[204:207], v41 offset:6144
    s_waitcnt vmcnt(19)
    v_mfma_f32_16x16x32_bf16 a[36:39], v[84:87], v[108:111], a[36:39]
    ds_read_b128 v[208:211], v40 offset:8192
    v_mfma_f32_16x16x32_bf16 a[40:43], v[84:87], v[116:119], a[40:43]
    ds_read_b128 v[212:215], v41 offset:8192
    v_mfma_f32_16x16x32_bf16 a[44:47], v[84:87], v[124:127], a[44:47]
    s_waitcnt vmcnt(17)
    v_mfma_f32_16x16x32_bf16 a[48:51], v[92:95], v[100:103], a[48:51]
    ds_read_b128 v[216:219], v40 offset:10240
    v_mfma_f32_16x16x32_bf16 a[52:55], v[92:95], v[108:111], a[52:55]
    ds_read_b128 v[220:223], v41 offset:10240
    v_mfma_f32_16x16x32_bf16 a[56:59], v[92:95], v[116:119], a[56:59]
    buffer_load_dwordx4 v[140:143], v47, s[24:27], 0 offen
    v_mfma_f32_16x16x32_bf16 a[60:63], v[92:95], v[124:127], a[60:63]
    s_waitcnt lgkmcnt(0)
    v_mfma_f32_16x16x32_bf16 a[0:3], v[160:163], v[192:195], a[0:3]
    s_waitcnt vmcnt(14)
    v_mfma_f32_16x16x32_bf16 a[4:7], v[160:163], v[200:203], a[4:7]
    ds_read_b128 v[64:67], v42 offset:12288
    v_mfma_f32_16x16x32_bf16 a[8:11], v[160:163], v[208:211], a[8:11]
    ds_read_b128 v[68:71], v43 offset:12288
    v_mfma_f32_16x16x32_bf16 a[12:15], v[160:163], v[216:219], a[12:15]
    v_mfma_f32_16x16x32_bf16 a[16:19], v[168:171], v[192:195], a[16:19]
    ds_read_b128 v[72:75], v42 offset:12800
    v_mfma_f32_16x16x32_bf16 a[20:23], v[168:171], v[200:203], a[20:23]
    ds_read_b128 v[76:79], v43 offset:12800
    v_mfma_f32_16x16x32_bf16 a[24:27], v[168:171], v[208:211], a[24:27]
    s_waitcnt vmcnt(10)
    v_mfma_f32_16x16x32_bf16 a[28:31], v[168:171], v[216:219], a[28:31]
    v_mfma_f32_16x16x32_bf16 a[32:35], v[176:179], v[192:195], a[32:35]
    ds_read_b128 v[80:83], v42 offset:16384
    v_mfma_f32_16x16x32_bf16 a[36:39], v[176:179], v[200:203], a[36:39]
    ds_read_b128 v[84:87], v43 offset:16384
    v_mfma_f32_16x16x32_bf16 a[40:43], v[176:179], v[208:211], a[40:43]
    v_mfma_f32_16x16x32_bf16 a[44:47], v[176:179], v[216:219], a[44:47]
    ds_read_b128 v[88:91], v42 offset:16896
    v_mfma_f32_16x16x32_bf16 a[48:51], v[184:187], v[192:195], a[48:51]
    ds_read_b128 v[92:95], v43 offset:16896
    v_mfma_f32_16x16x32_bf16 a[52:55], v[184:187], v[200:203], a[52:55]
    s_waitcnt vmcnt(8)
    v_mfma_f32_16x16x32_bf16 a[56:59], v[184:187], v[208:211], a[56:59]
    v_mfma_f32_16x16x32_bf16 a[60:63], v[184:187], v[216:219], a[60:63]
    ds_read_b128 v[96:99], v40 offset:20480
    v_mfma_f32_16x16x32_bf16 a[0:3], v[164:167], v[196:199], a[0:3]
    ds_read_b128 v[100:103], v41 offset:20480
    v_mfma_f32_16x16x32_bf16 a[4:7], v[164:167], v[204:207], a[4:7]
    v_mfma_f32_16x16x32_bf16 a[8:11], v[164:167], v[212:215], a[8:11]
    s_waitcnt vmcnt(6)
    v_mfma_f32_16x16x32_bf16 a[12:15], v[164:167], v[220:223], a[12:15]
    ds_read_b128 v[104:107], v40 offset:22528
    v_mfma_f32_16x16x32_bf16 a[16:19], v[172:175], v[196:199], a[16:19]
    ds_read_b128 v[108:111], v41 offset:22528
    v_mfma_f32_16x16x32_bf16 a[20:23], v[172:175], v[204:207], a[20:23]
    v_mfma_f32_16x16x32_bf16 a[24:27], v[172:175], v[212:215], a[24:27]
    s_waitcnt vmcnt(3)
    v_mfma_f32_16x16x32_bf16 a[28:31], v[172:175], v[220:223], a[28:31]
    ds_read_b128 v[112:115], v40 offset:24576
    v_mfma_f32_16x16x32_bf16 a[32:35], v[180:183], v[196:199], a[32:35]
    v_mfma_f32_16x16x32_bf16 a[36:39], v[180:183], v[204:207], a[36:39]
    ds_read_b128 v[116:119], v41 offset:24576
    v_mfma_f32_16x16x32_bf16 a[40:43], v[180:183], v[212:215], a[40:43]
    s_waitcnt vmcnt(1)
    v_mfma_f32_16x16x32_bf16 a[44:47], v[180:183], v[220:223], a[44:47]
    ds_read_b128 v[120:123], v40 offset:26624
    v_mfma_f32_16x16x32_bf16 a[48:51], v[188:191], v[196:199], a[48:51]
    v_mfma_f32_16x16x32_bf16 a[52:55], v[188:191], v[204:207], a[52:55]
    ds_read_b128 v[124:127], v41 offset:26624
    v_mfma_f32_16x16x32_bf16 a[56:59], v[188:191], v[212:215], a[56:59]
    s_waitcnt lgkmcnt(0)
    v_mfma_f32_16x16x32_bf16 a[60:63], v[188:191], v[220:223], a[60:63]
    v_mfma_f32_16x16x32_bf16 a[0:3], v[64:67], v[96:99], a[0:3]
    v_mfma_f32_16x16x32_bf16 a[4:7], v[64:67], v[104:107], a[4:7]
    v_mfma_f32_16x16x32_bf16 a[8:11], v[64:67], v[112:115], a[8:11]
    v_mfma_f32_16x16x32_bf16 a[12:15], v[64:67], v[120:123], a[12:15]
    v_mfma_f32_16x16x32_bf16 a[16:19], v[72:75], v[96:99], a[16:19]
    v_mfma_f32_16x16x32_bf16 a[20:23], v[72:75], v[104:107], a[20:23]
    v_mfma_f32_16x16x32_bf16 a[24:27], v[72:75], v[112:115], a[24:27]
    v_mfma_f32_16x16x32_bf16 a[28:31], v[72:75], v[120:123], a[28:31]
    v_mfma_f32_16x16x32_bf16 a[32:35], v[80:83], v[96:99], a[32:35]
    v_mfma_f32_16x16x32_bf16 a[36:39], v[80:83], v[104:107], a[36:39]
    v_mfma_f32_16x16x32_bf16 a[40:43], v[80:83], v[112:115], a[40:43]
    v_mfma_f32_16x16x32_bf16 a[44:47], v[80:83], v[120:123], a[44:47]
    v_mfma_f32_16x16x32_bf16 a[48:51], v[88:91], v[96:99], a[48:51]
    v_mfma_f32_16x16x32_bf16 a[52:55], v[88:91], v[104:107], a[52:55]
    v_mfma_f32_16x16x32_bf16 a[56:59], v[88:91], v[112:115], a[56:59]
    v_mfma_f32_16x16x32_bf16 a[60:63], v[88:91], v[120:123], a[60:63]
    v_mfma_f32_16x16x32_bf16 a[0:3], v[68:71], v[100:103], a[0:3]
    v_mfma_f32_16x16x32_bf16 a[4:7], v[68:71], v[108:111], a[4:7]
    v_mfma_f32_16x16x32_bf16 a[8:11], v[68:71], v[116:119], a[8:11]
    v_mfma_f32_16x16x32_bf16 a[12:15], v[68:71], v[124:127], a[12:15]
    v_mfma_f32_16x16x32_bf16 a[16:19], v[76:79], v[100:103], a[16:19]
    v_mfma_f32_16x16x32_bf16 a[20:23], v[76:79], v[108:111], a[20:23]
    v_mfma_f32_16x16x32_bf16 a[24:27], v[76:79], v[116:119], a[24:27]
    v_mfma_f32_16x16x32_bf16 a[28:31], v[76:79], v[124:127], a[28:31]
    v_mfma_f32_16x16x32_bf16 a[32:35], v[84:87], v[100:103], a[32:35]
    v_mfma_f32_16x16x32_bf16 a[36:39], v[84:87], v[108:111], a[36:39]
    v_mfma_f32_16x16x32_bf16 a[40:43], v[84:87], v[116:119], a[40:43]
    v_mfma_f32_16x16x32_bf16 a[44:47], v[84:87], v[124:127], a[44:47]
    v_mfma_f32_16x16x32_bf16 a[48:51], v[92:95], v[100:103], a[48:51]
    v_mfma_f32_16x16x32_bf16 a[52:55], v[92:95], v[108:111], a[52:55]
    v_mfma_f32_16x16x32_bf16 a[56:59], v[92:95], v[116:119], a[56:59]
    v_mfma_f32_16x16x32_bf16 a[60:63], v[92:95], v[124:127], a[60:63]
    s_nop 7
    s_nop 7
    s_cmp_lg_u32 s21, 0
    s_cbranch_scc1 KB_ZW_0
    ds_write_b128 v50, a[32:35] offset:0
    ds_write_b128 v50, a[48:51] offset:1024
    ds_write_b128 v50, a[36:39] offset:2048
    ds_write_b128 v50, a[52:55] offset:3072
    ds_write_b128 v50, a[8:11] offset:4096
    ds_write_b128 v50, a[24:27] offset:5120
    ds_write_b128 v50, a[12:15] offset:6144
    ds_write_b128 v50, a[28:31] offset:7168
    ds_write_b128 v50, a[40:43] offset:8192
    ds_write_b128 v50, a[56:59] offset:9216
    ds_write_b128 v50, a[44:47] offset:10240
    ds_write_b128 v50, a[60:63] offset:11264
    v_accvgpr_read_b32 v64, a0
    v_accvgpr_read_b32 v65, a1
    v_accvgpr_read_b32 v66, a2
    v_accvgpr_read_b32 v67, a3
    v_accvgpr_read_b32 v68, a16
    v_accvgpr_read_b32 v69, a17
    v_accvgpr_read_b32 v70, a18
    v_accvgpr_read_b32 v71, a19
    v_accvgpr_read_b32 v72, a4
    v_accvgpr_read_b32 v73, a5
    v_accvgpr_read_b32 v74, a6
    v_accvgpr_read_b32 v75, a7
    v_accvgpr_read_b32 v76, a20
    v_accvgpr_read_b32 v77, a21
    v_accvgpr_read_b32 v78, a22
    v_accvgpr_read_b32 v79, a23
KB_ZW_0:
    s_cmp_lg_u32 s21, 1
    s_cbranch_scc1 KB_ZW_1
    ds_write_b128 v50, a[0:3] offset:8192
    ds_write_b128 v50, a[16:19] offset:9216
    ds_write_b128 v50, a[4:7] offset:10240
    ds_write_b128 v50, a[20:23] offset:11264
    ds_write_b128 v50, a[8:11] offset:0
    ds_write_b128 v50, a[24:27] offset:1024
    ds_write_b128 v50, a[12:15] offset:2048
    ds_write_b128 v50, a[28:31] offset:3072
    ds_write_b128 v50, a[40:43] offset:4096
    ds_write_b128 v50, a[56:59] offset:5120
    ds_write_b128 v50, a[44:47] offset:6144
    ds_write_b128 v50, a[60:63] offset:7168
    v_accvgpr_read_b32 v64, a32
    v_accvgpr_read_b32 v65, a33
    v_accvgpr_read_b32 v66, a34
    v_accvgpr_read_b32 v67, a35
    v_accvgpr_read_b32 v68, a48
    v_accvgpr_read_b32 v69, a49
    v_accvgpr_read_b32 v70, a50
    v_accvgpr_read_b32 v71, a51
    v_accvgpr_read_b32 v72, a36
    v_accvgpr_read_b32 v73, a37
    v_accvgpr_read_b32 v74, a38
    v_accvgpr_read_b32 v75, a39
    v_accvgpr_read_b32 v76, a52
    v_accvgpr_read_b32 v77, a53
    v_accvgpr_read_b32 v78, a54
    v_accvgpr_read_b32 v79, a55
KB_ZW_1:
    s_cmp_lg_u32 s21, 2
    s_cbranch_scc1 KB_ZW_2
    ds_write_b128 v50, a[0:3] offset:4096
    ds_write_b128 v50, a[16:19] offset:5120
    ds_write_b128 v50, a[4:7] offset:6144
    ds_write_b128 v50, a[20:23] offset:7168
    ds_write_b128 v50, a[32:35] offset:8192
    ds_write_b128 v50, a[48:51] offset:9216
    ds_write_b128 v50, a[36:39] offset:10240
    ds_write_b128 v50, a[52:55] offset:11264
    ds_write_b128 v50, a[40:43] offset:0
    ds_write_b128 v50, a[56:59] offset:1024
    ds_write_b128 v50, a[44:47] offset:2048
    ds_write_b128 v50, a[60:63] offset:3072
    v_accvgpr_read_b32 v64, a8
    v_accvgpr_read_b32 v65, a9
    v_accvgpr_read_b32 v66, a10
    v_accvgpr_read_b32 v67, a11
    v_accvgpr_read_b32 v68, a24
    v_accvgpr_read_b32 v69, a25
    v_accvgpr_read_b32 v70, a26
    v_accvgpr_read_b32 v71, a27
    v_accvgpr_read_b32 v72, a12
    v_accvgpr_read_b32 v73, a13
    v_accvgpr_read_b32 v74, a14
    v_accvgpr_read_b32 v75, a15
    v_accvgpr_read_b32 v76, a28
    v_accvgpr_read_b32 v77, a29
    v_accvgpr_read_b32 v78, a30
    v_accvgpr_read_b32 v79, a31
KB_ZW_2:
    s_cmp_lg_u32 s21, 3
    s_cbranch_scc1 KB_ZW_3
    ds_write_b128 v50, a[0:3] offset:0
    ds_write_b128 v50, a[16:19] offset:1024
    ds_write_b128 v50, a[4:7] offset:2048
    ds_write_b128 v50, a[20:23] offset:3072
    ds_write_b128 v50, a[32:35] offset:4096
    ds_write_b128 v50, a[48:51] offset:5120
    ds_write_b128 v50, a[36:39] offset:6144
    ds_write_b128 v50, a[52:55] offset:7168
    ds_write_b128 v50, a[8:11] offset:8192
    ds_write_b128 v50, a[24:27] offset:9216
    ds_write_b128 v50, a[12:15] offset:10240
    ds_write_b128 v50, a[28:31] offset:11264
    v_accvgpr_read_b32 v64, a40
    v_accvgpr_read_b32 v65, a41
    v_accvgpr_read_b32 v66, a42
    v_accvgpr_read_b32 v67, a43
    v_accvgpr_read_b32 v68, a56
    v_accvgpr_read_b32 v69, a57
    v_accvgpr_read_b32 v70, a58
    v_accvgpr_read_b32 v71, a59
    v_accvgpr_read_b32 v72, a44
    v_accvgpr_read_b32 v73, a45
    v_accvgpr_read_b32 v74, a46
    v_accvgpr_read_b32 v75, a47
    v_accvgpr_read_b32 v76, a60
    v_accvgpr_read_b32 v77, a61
    v_accvgpr_read_b32 v78, a62
    v_accvgpr_read_b32 v79, a63
KB_ZW_3:
    s_waitcnt lgkmcnt(0)
    s_barrier
    ds_read_b128 v[80:83], v51 offset:0
    ds_read_b128 v[84:87], v51 offset:1024
    ds_read_b128 v[88:91], v51 offset:2048
    ds_read_b128 v[92:95], v51 offset:3072
    ds_read_b128 v[96:99], v52 offset:4096
    ds_read_b128 v[100:103], v52 offset:5120
    ds_read_b128 v[104:107], v52 offset:6144
    ds_read_b128 v[108:111], v52 offset:7168
    ds_read_b128 v[112:115], v53 offset:8192
    ds_read_b128 v[116:119], v53 offset:9216
    ds_read_b128 v[120:123], v53 offset:10240
    ds_read_b128 v[124:127], v53 offset:11264
    s_waitcnt lgkmcnt(8)
    v_add_f32 v64, v64, v80
    v_add_f32 v65, v65, v81
    v_add_f32 v66, v66, v82
    v_add_f32 v67, v67, v83
    v_add_f32 v68, v68, v84
    v_add_f32 v69, v69, v85
    v_add_f32 v70, v70, v86
    v_add_f32 v71, v71, v87
    v_add_f32 v72, v72, v88
    v_add_f32 v73, v73, v89
    v_add_f32 v74, v74, v90
    v_add_f32 v75, v75, v91
    v_add_f32 v76, v76, v92
    v_add_f32 v77, v77, v93
    v_add_f32 v78, v78, v94
    v_add_f32 v79, v79, v95
    s_waitcnt lgkmcnt(4)
    v_add_f32 v64, v64, v96
    v_add_f32 v65, v65, v97
    v_add_f32 v66, v66, v98
    v_add_f32 v67, v67, v99
    v_add_f32 v68, v68, v100
    v_add_f32 v69, v69, v101
    v_add_f32 v70, v70, v102
    v_add_f32 v71, v71, v103
    v_add_f32 v72, v72, v104
    v_add_f32 v73, v73, v105
    v_add_f32 v74, v74, v106
    v_add_f32 v75, v75, v107
    v_add_f32 v76, v76, v108
    v_add_f32 v77, v77, v109
    v_add_f32 v78, v78, v110
    v_add_f32 v79, v79, v111
    s_waitcnt lgkmcnt(0)
    v_add_f32 v64, v64, v112
    v_add_f32 v65, v65, v113
    v_add_f32 v66, v66, v114
    v_add_f32 v67, v67, v115
    v_add_f32 v68, v68, v116
    v_add_f32 v69, v69, v117
    v_add_f32 v70, v70, v118
    v_add_f32 v71, v71, v119
    v_add_f32 v72, v72, v120
    v_add_f32 v73, v73, v121
    v_add_f32 v74, v74, v122
    v_add_f32 v75, v75, v123
    v_add_f32 v76, v76, v124
    v_add_f32 v77, v77, v125
    v_add_f32 v78, v78, v126
    v_add_f32 v79, v79, v127
    s_waitcnt vmcnt(0)
    s_cmp_lg_u32 s77, 0
    s_cbranch_scc1 KB_FIN_0
    v_add_f32 v64, v64, v128
    v_lshlrev_b32 v152, 16, v136
    v_add_f32 v64, v64, v152
    v_add_f32 v65, v65, v129
    v_and_b32 v153, 0xffff0000, v136
    v_add_f32 v65, v65, v153
    v_add_f32 v66, v66, v130
    v_lshlrev_b32 v154, 16, v137
    v_add_f32 v66, v66, v154
    v_add_f32 v67, v67, v131
    v_and_b32 v155, 0xffff0000, v137
    v_add_f32 v67, v67, v155
    v_add_f32 v68, v68, v132
    v_lshlrev_b32 v152, 16, v138
    v_add_f32 v68, v68, v152
    v_add_f32 v69, v69, v133
    v_and_b32 v153, 0xffff0000, v138
    v_add_f32 v69, v69, v153
    v_add_f32 v70, v70, v134
    v_lshlrev_b32 v154, 16, v139
    v_add_f32 v70, v70, v154
    v_add_f32 v71, v71, v135
    v_and_b32 v155, 0xffff0000, v139
    v_add_f32 v71, v71, v155
    v_cvt_pk_bf16_f32 v144, v64, v65
    v_cvt_pk_bf16_f32 v145, v66, v67
    v_cvt_pk_bf16_f32 v146, v68, v69
    v_cvt_pk_bf16_f32 v147, v70, v71
    v_add_f32 v72, v72, v224
    v_lshlrev_b32 v152, 16, v140
    v_add_f32 v72, v72, v152
    v_add_f32 v73, v73, v225
    v_and_b32 v153, 0xffff0000, v140
    v_add_f32 v73, v73, v153
    v_add_f32 v74, v74, v226
    v_lshlrev_b32 v154, 16, v141
    v_add_f32 v74, v74, v154
    v_add_f32 v75, v75, v227
    v_and_b32 v155, 0xffff0000, v141
    v_add_f32 v75, v75, v155
    v_add_f32 v76, v76, v228
    v_lshlrev_b32 v152, 16, v142
    v_add_f32 v76, v76, v152
    v_add_f32 v77, v77, v229
    v_and_b32 v153, 0xffff0000, v142
    v_add_f32 v77, v77, v153
    v_add_f32 v78, v78, v230
    v_lshlrev_b32 v154, 16, v143
    v_add_f32 v78, v78, v154
    v_add_f32 v79, v79, v231
    v_and_b32 v155, 0xffff0000, v143
    v_add_f32 v79, v79, v155
    v_cvt_pk_bf16_f32 v148, v72, v73
    v_cvt_pk_bf16_f32 v149, v74, v75
    v_cvt_pk_bf16_f32 v150, v76, v77
    v_cvt_pk_bf16_f32 v151, v78, v79
KB_FIN_0:
    s_cmp_lg_u32 s77, 1
    s_cbranch_scc1 KB_FIN_1
    v_add_f32 v64, v64, v135
    v_lshlrev_b32 v152, 16, v136
    v_add_f32 v64, v64, v152
    v_add_f32 v65, v65, v134
    v_and_b32 v153, 0xffff0000, v136
    v_add_f32 v65, v65, v153
    v_add_f32 v66, v66, v133
    v_lshlrev_b32 v154, 16, v137
    v_add_f32 v66, v66, v154
    v_add_f32 v67, v67, v132
    v_and_b32 v155, 0xffff0000, v137
    v_add_f32 v67, v67, v155
    v_add_f32 v68, v68, v131
    v_lshlrev_b32 v152, 16, v138
    v_add_f32 v68, v68, v152
    v_add_f32 v69, v69, v130
    v_and_b32 v153, 0xffff0000, v138
    v_add_f32 v69, v69, v153
    v_add_f32 v70, v70, v129
    v_lshlrev_b32 v154, 16, v139
    v_add_f32 v70, v70, v154
    v_add_f32 v71, v71, v128
    v_and_b32 v155, 0xffff0000, v139
    v_add_f32 v71, v71, v155
    v_cvt_pk_bf16_f32 v144, v64, v65
    v_cvt_pk_bf16_f32 v145, v66, v67
    v_cvt_pk_bf16_f32 v146, v68, v69
    v_cvt_pk_bf16_f32 v147, v70, v71
    v_add_f32 v72, v72, v231
    v_lshlrev_b32 v152, 16, v140
    v_add_f32 v72, v72, v152
    v_add_f32 v73, v73, v230
    v_and_b32 v153, 0xffff0000, v140
    v_add_f32 v73, v73, v153
    v_add_f32 v74, v74, v229
    v_lshlrev_b32 v154, 16, v141
    v_add_f32 v74, v74, v154
    v_add_f32 v75, v75, v228
    v_and_b32 v155, 0xffff0000, v141
    v_add_f32 v75, v75, v155
    v_add_f32 v76, v76, v227
    v_lshlrev_b32 v152, 16, v142
    v_add_f32 v76, v76, v152
    v_add_f32 v77, v77, v226
    v_and_b32 v153, 0xffff0000, v142
    v_add_f32 v77, v77, v153
    v_add_f32 v78, v78, v225
    v_lshlrev_b32 v154, 16, v143
    v_add_f32 v78, v78, v154
    v_add_f32 v79, v79, v224
    v_and_b32 v155, 0xffff0000, v143
    v_add_f32 v79, v79, v155
    v_cvt_pk_bf16_f32 v148, v72, v73
    v_cvt_pk_bf16_f32 v149, v74, v75
    v_cvt_pk_bf16_f32 v150, v76, v77
    v_cvt_pk_bf16_f32 v151, v78, v79
KB_FIN_1:
    s_nop 1
    buffer_store_dwordx4 v[144:147], v46, s[28:31], 0 offen
    buffer_store_dwordx4 v[148:151], v47, s[28:31], 0 offen
KB_END:
    s_endpgm
.section .rodata,"a"
.p2align 6
.amdhsa_kernel fnet_ka_kernel
  .amdhsa_next_free_vgpr 308
  .amdhsa_next_free_sgpr 96
  .amdhsa_accum_offset 256
  .amdhsa_group_segment_fixed_size 0
  .amdhsa_kernarg_size 88
  .amdhsa_user_sgpr_count 2
  .amdhsa_user_sgpr_kernarg_segment_ptr 1
  .amdhsa_system_sgpr_workgroup_id_x 1
.end_amdhsa_kernel
.p2align 6
.amdhsa_kernel fnet_kb_kernel
  .amdhsa_next_free_vgpr 392
  .amdhsa_next_free_sgpr 96
  .amdhsa_accum_offset 256
  .amdhsa_group_segment_fixed_size 0
  .amdhsa_kernarg_size 88
  .amdhsa_user_sgpr_count 2
  .amdhsa_user_sgpr_kernarg_segment_ptr 1
  .amdhsa_system_sgpr_workgroup_id_x 1
.end_amdhsa_kernel
```
